```python
import torch

def _softmax(x, axis=-1):
    return torch.softmax(x, dim=axis)
def _gelu(x):
    return torch.nn.functional.gelu(x, approximate="tanh")
def _silu(x):
    return torch.nn.functional.silu(x)
def _sigmoid(x):
    return torch.sigmoid(x)
def _layernorm(x, axis=-1, eps=1e-5):
    m = x.mean(dim=axis, keepdim=True)
    v = x.var(dim=axis, keepdim=True, unbiased=False)
    return (x - m) / torch.sqrt(v + eps)
def _scatter_add(tgt, idx, src, axis=0):
    return tgt.clone().index_add_(axis, idx, src)
def _segment_sum(src, seg, n):
    out = torch.zeros((n,) + src.shape[1:], dtype=src.dtype)
    return out.index_add_(0, seg, src)
def _pad(x, pw):
    flat = tuple(v for pair in reversed(pw) for v in pair)
    return torch.nn.functional.pad(x, flat)

kernel_name = 'gather_scatter__edge_featured_mpnn_egc__graph'

def setup_inputs():

    _w = (lambda a: (lambda t: t.to(torch.bfloat16) if t.is_floating_point() else t)(torch.as_tensor(a)))
    N, deg, D, De = 25000, 16, 128, max(16, 1)
    E = N * deg
    return {
        "x": _w((lambda *s: torch.randn(*s, dtype=torch.bfloat16) * 0.2)(N, D)),
        "e_attr": _w((lambda *s: torch.randn(*s, dtype=torch.bfloat16) * 0.2)(E, De)),
        "src": _w((lambda lo, hi, *s: torch.randint(lo, hi, s))(0, N, E).to(torch.int64)),
        "dst": _w((lambda lo, hi, *s: torch.randint(lo, hi, s))(0, N, E).to(torch.int64)),
        "u_w": _w((lambda *s: torch.randn(*s, dtype=torch.bfloat16) * 0.05)(D, D)),
        "v_w": _w((lambda *s: torch.randn(*s, dtype=torch.bfloat16) * 0.05)(D, D)),
        "g_w": _w((lambda *s: torch.randn(*s, dtype=torch.bfloat16) * 0.2)(2 * D + De, D)),
    }

def reference(x, e_attr, src, dst, u_w, v_w, g_w):
    N, D = x.shape
    g_in = torch.concatenate([x[dst], x[src], e_attr], axis=-1)
    eta = _sigmoid(g_in @ g_w)
    hv = x @ v_w
    msg = eta * hv[src]
    agg = _segment_sum(msg, dst, N)
    return _silu(x @ u_w + agg)
```

```asm
; @launch kernel=prep_kernel grid=(256,1,1) block=(1024,1,1) lds=150784
; @launch kernel=main_kernel grid=(256,1,1) block=(1024,1,1) lds=160800
.amdgcn_target "amdgcn-amd-amdhsa--gfx950"
.text
.globl prep_kernel
.type prep_kernel,@function
.globl main_kernel
.type main_kernel,@function
.p2align 8
prep_kernel:
    s_cmp_ge_u32 s2, 256
    s_cbranch_scc1 L_k1_end
    s_load_dwordx4 s[4:7], s[0:1], 0
    s_load_dwordx4 s[8:11], s[0:1], 16
    s_load_dwordx4 s[12:15], s[0:1], 32
    s_load_dwordx2 s[16:17], s[0:1], 48
    s_load_dwordx2 s[18:19], s[0:1], 72
    v_lshrrev_b32 v1, 6, v0
    v_and_b32 v2, 63, v0
    v_readfirstlane_b32 s3, v1
    v_lshlrev_b32 v3, 4, v2
    v_lshlrev_b32 v4, 4, v0
    s_waitcnt lgkmcnt(0)
    s_cmp_ge_u32 s2, 16
    s_cbranch_scc1 L_k1_nocpf
    s_getpc_b64 s[20:21]
L_k1_pc:
    s_sub_u32 s20, s20, L_k1_pc-prep_kernel
    s_subb_u32 s21, s21, 0
    global_load_dwordx4 v[120:123], v4, s[20:21]
L_k1_nocpf:
    s_add_u32 s44, s18, 0x3100000
    s_addc_u32 s45, s19, 0
    s_mov_b32 s46, 0x13000
    s_mov_b32 s47, 0x20000
    s_cmp_ge_u32 s2, 128
    s_cbranch_scc1 L_k1_gemm
    s_mov_b32 s20, s10
    s_mov_b32 s21, s11
    s_mov_b32 s22, 0x186a00
    s_mov_b32 s23, 0x20000
    s_mov_b32 s24, s8
    s_mov_b32 s25, s9
    s_mov_b32 s26, 0x186a00
    s_mov_b32 s27, 0x20000
    s_mov_b32 s28, s6
    s_mov_b32 s29, s7
    s_mov_b32 s30, 0xc35000
    s_mov_b32 s31, 0x20000
    s_add_u32 s32, s18, 0xd00000
    s_addc_u32 s33, s19, 0
    s_mov_b32 s34, 0x400000
    s_mov_b32 s35, 0x20000
    s_add_u32 s36, s18, 0x1100000
    s_addc_u32 s37, s19, 0
    s_mov_b32 s38, 0x2000000
    s_mov_b32 s39, 0x20000
    s_mul_i32 s50, s2, 3136
    s_sub_u32 s51, 400000, s50
    s_lshr_b32 s51, s51, 2
    s_min_u32 s51, s51, 784
    s_lshl_b32 s52, s50, 2
    v_cmp_gt_u32 vcc, s51, v0
    s_mov_b64 s[54:55], vcc
    s_mov_b64 exec, vcc
    s_cbranch_execz L_k1_noidx
    buffer_load_dwordx4 v[8:11], v4, s[20:23], s52 offen
    buffer_load_dwordx4 v[12:15], v4, s[24:27], s52 offen
L_k1_noidx:
    s_mov_b64 exec, -1
    s_lshl_b32 s53, s3, 10
    s_lshl_b32 s56, s50, 5
    s_add_u32 s56, s56, s53
    v_mov_b32 v16, -1
    v_mov_b32 v17, -1
    v_mov_b32 v18, -1
    v_mov_b32 v19, -1
    v_mov_b32 v20, 0
    v_add_u32 v5, 100352, v4
    v_lshlrev_b32 v6, 2, v0
    v_add_u32 v6, 149504, v6
    ds_write_b128 v5, v[16:19]
    ds_write_b128 v5, v[16:19] offset:16384
    v_cmp_gt_u32 vcc, 0x140, v0
    s_mov_b64 exec, vcc
    ds_write_b32 v6, v20
    s_mov_b64 exec, -1
    v_mov_b32 v20, 1
    v_mov_b32 v22, 21400
    v_mov_b32 v23, -196
    v_mov_b32 v24, 5372
    v_mov_b32 v25, 208
    v_mov_b32 v26, 669
    s_waitcnt lgkmcnt(0)
    s_barrier
    s_mov_b32 m0, s53
    s_add_u32 s53, s53, 16384
    buffer_load_dwordx4 v3, s[28:31], s56 offen  lds
    s_add_u32 s56, s56, 16384
    s_mov_b32 m0, s53
    s_add_u32 s53, s53, 16384
    buffer_load_dwordx4 v3, s[28:31], s56 offen  lds
    s_add_u32 s56, s56, 16384
    s_mov_b32 m0, s53
    s_add_u32 s53, s53, 16384
    buffer_load_dwordx4 v3, s[28:31], s56 offen  lds
    s_add_u32 s56, s56, 16384
    s_mov_b32 m0, s53
    s_add_u32 s53, s53, 16384
    buffer_load_dwordx4 v3, s[28:31], s56 offen  lds
    s_add_u32 s56, s56, 16384
    s_mov_b32 m0, s53
    s_add_u32 s53, s53, 16384
    buffer_load_dwordx4 v3, s[28:31], s56 offen  lds
    s_add_u32 s56, s56, 16384
    s_mov_b32 m0, s53
    s_add_u32 s53, s53, 16384
    buffer_load_dwordx4 v3, s[28:31], s56 offen  lds
    s_add_u32 s56, s56, 16384
    s_cmp_ge_u32 s3, 2
    s_cbranch_scc1 L_k1_dmadone
    s_mov_b32 m0, s53
    s_add_u32 s53, s53, 16384
    buffer_load_dwordx4 v3, s[28:31], s56 offen  lds
    s_add_u32 s56, s56, 16384
L_k1_dmadone:
    s_waitcnt vmcnt(6)
    s_mov_b64 exec, s[54:55]
    s_cbranch_execz L_k1_b1
    v_mul_u32_u24 v60, v8, v22
    v_mul_u32_u24 v61, v12, v26
    v_lshrrev_b32 v28, 22, v60
    v_lshrrev_b32 v61, 22, v61
    v_lshlrev_b32 v36, 2, v28
    v_sub_u32_e64 v40, v61, 1 clamp
    v_add_u32 v36, 149504, v36
    v_lshlrev_b32 v40, 3, v40
    v_mad_i32_i24 v60, v28, v23, v8
    v_lshlrev_b32 v48, v40, v20
    v_mul_u32_u24 v62, v60, v24
    ds_add_rtn_u32 v44, v36, v48
    v_lshl_or_b32 v60, v12, 8, v60
    v_lshrrev_b32 v62, 16, v62
    v_mad_u32_u24 v63, v62, 52, v25
    v_mad_i32_i24 v60, v62, -12, v60
    v_lshrrev_b32 v63, 8, v63
    v_lshl_add_u32 v62, v62, 2, v61
    v_sub_u32 v60, v60, v63
    v_lshl_or_b32 v32, v62, 24, v60
    v_mul_u32_u24 v60, v9, v22
    v_mul_u32_u24 v61, v13, v26
    v_lshrrev_b32 v29, 22, v60
    v_lshrrev_b32 v61, 22, v61
    v_lshlrev_b32 v37, 2, v29
    v_sub_u32_e64 v41, v61, 1 clamp
    v_add_u32 v37, 149504, v37
    v_lshlrev_b32 v41, 3, v41
    v_mad_i32_i24 v60, v29, v23, v9
    v_lshlrev_b32 v49, v41, v20
    v_mul_u32_u24 v62, v60, v24
    ds_add_rtn_u32 v45, v37, v49
    v_lshl_or_b32 v60, v13, 8, v60
    v_lshrrev_b32 v62, 16, v62
    v_mad_u32_u24 v63, v62, 52, v25
    v_mad_i32_i24 v60, v62, -12, v60
    v_lshrrev_b32 v63, 8, v63
    v_lshl_add_u32 v62, v62, 2, v61
    v_sub_u32 v60, v60, v63
    v_lshl_or_b32 v33, v62, 24, v60
    v_mul_u32_u24 v60, v10, v22
    v_mul_u32_u24 v61, v14, v26
    v_lshrrev_b32 v30, 22, v60
    v_lshrrev_b32 v61, 22, v61
    v_lshlrev_b32 v38, 2, v30
    v_sub_u32_e64 v42, v61, 1 clamp
    v_add_u32 v38, 149504, v38
    v_lshlrev_b32 v42, 3, v42
    v_mad_i32_i24 v60, v30, v23, v10
    v_lshlrev_b32 v50, v42, v20
    v_mul_u32_u24 v62, v60, v24
    ds_add_rtn_u32 v46, v38, v50
    v_lshl_or_b32 v60, v14, 8, v60
    v_lshrrev_b32 v62, 16, v62
    v_mad_u32_u24 v63, v62, 52, v25
    v_mad_i32_i24 v60, v62, -12, v60
    v_lshrrev_b32 v63, 8, v63
    v_lshl_add_u32 v62, v62, 2, v61
    v_sub_u32 v60, v60, v63
    v_lshl_or_b32 v34, v62, 24, v60
    v_mul_u32_u24 v60, v11, v22
    v_mul_u32_u24 v61, v15, v26
    v_lshrrev_b32 v31, 22, v60
    v_lshrrev_b32 v61, 22, v61
    v_lshlrev_b32 v39, 2, v31
    v_sub_u32_e64 v43, v61, 1 clamp
    v_add_u32 v39, 149504, v39
    v_lshlrev_b32 v43, 3, v43
    v_mad_i32_i24 v60, v31, v23, v11
    v_lshlrev_b32 v51, v43, v20
    v_mul_u32_u24 v62, v60, v24
    ds_add_rtn_u32 v47, v39, v51
    v_lshl_or_b32 v60, v15, 8, v60
    v_lshrrev_b32 v62, 16, v62
    v_mad_u32_u24 v63, v62, 52, v25
    v_mad_i32_i24 v60, v62, -12, v60
    v_lshrrev_b32 v63, 8, v63
    v_lshl_add_u32 v62, v62, 2, v61
    v_sub_u32 v60, v60, v63
    v_lshl_or_b32 v35, v62, 24, v60
L_k1_b1:
    s_mov_b64 exec, -1
    s_waitcnt lgkmcnt(0)
    s_barrier
    s_mov_b64 s[70:71], 0
    v_cmp_gt_u32 vcc, 128, v0
    s_mov_b64 exec, vcc
    s_cbranch_execz L_k1_nohdr
    ds_read_b32 v60, v6
    v_lshlrev_b32 v61, 8, v0
    v_add_u32 v61, 100476, v61
    s_waitcnt lgkmcnt(0)
    v_and_b32 v60, 0x3f3f3f, v60
    ds_write_b32 v61, v60
L_k1_nohdr:
    s_mov_b64 exec, s[54:55]
    s_cbranch_execz L_k1_b2
    ds_read_b32 v8, v36
    ds_read_b32 v9, v37
    ds_read_b32 v10, v38
    ds_read_b32 v11, v39
    v_lshlrev_b32 v68, 2, v0
    v_bfe_u32 v44, v44, v40, 8
    v_add_u32 v48, -1, v48
    v_bfe_u32 v45, v45, v41, 8
    v_add_u32 v49, -1, v49
    v_bfe_u32 v46, v46, v42, 8
    v_add_u32 v50, -1, v50
    v_bfe_u32 v47, v47, v43, 8
    v_add_u32 v51, -1, v51
    s_waitcnt lgkmcnt(0)
    v_and_b32 v60, v8, v48
    v_sad_u8 v60, v60, 0, v44
    v_cmp_lt_u32 vcc, 62, v60
    v_min_u32 v60, 62, v60
    s_or_b64 s[70:71], s[70:71], vcc
    v_cmp_lt_u32 vcc, 30, v60
    v_lshl_add_u32 v61, v28, 6, v60
    v_lshlrev_b32 v61, 1, v61
    v_addc_co_u32 v60, vcc, 0, v60, vcc
    v_add_u32 v61, 133120, v61
    v_and_b32 v62, 7, v60
    v_bfe_u32 v63, v60, 3, 2
    v_and_or_b32 v63, v60, 32, v63
    v_lshl_add_u32 v62, v62, 2, v63
    v_lshl_add_u32 v62, v28, 6, v62
    v_add_u32 v69, 0, v68
    v_lshlrev_b32 v62, 2, v62
    ds_write_b16 v61, v69
    v_add_u32 v62, 100352, v62
    ds_write_b32 v62, v32
    v_and_b32 v60, v9, v49
    v_sad_u8 v60, v60, 0, v45
    v_cmp_lt_u32 vcc, 62, v60
    v_min_u32 v60, 62, v60
    s_or_b64 s[70:71], s[70:71], vcc
    v_cmp_lt_u32 vcc, 30, v60
    v_lshl_add_u32 v61, v29, 6, v60
    v_lshlrev_b32 v61, 1, v61
    v_addc_co_u32 v60, vcc, 0, v60, vcc
    v_add_u32 v61, 133120, v61
    v_and_b32 v62, 7, v60
    v_bfe_u32 v63, v60, 3, 2
    v_and_or_b32 v63, v60, 32, v63
    v_lshl_add_u32 v62, v62, 2, v63
    v_lshl_add_u32 v62, v29, 6, v62
    v_add_u32 v69, 1, v68
    v_lshlrev_b32 v62, 2, v62
    ds_write_b16 v61, v69
    v_add_u32 v62, 100352, v62
    ds_write_b32 v62, v33
    v_and_b32 v60, v10, v50
    v_sad_u8 v60, v60, 0, v46
    v_cmp_lt_u32 vcc, 62, v60
    v_min_u32 v60, 62, v60
    s_or_b64 s[70:71], s[70:71], vcc
    v_cmp_lt_u32 vcc, 30, v60
    v_lshl_add_u32 v61, v30, 6, v60
    v_lshlrev_b32 v61, 1, v61
    v_addc_co_u32 v60, vcc, 0, v60, vcc
    v_add_u32 v61, 133120, v61
    v_and_b32 v62, 7, v60
    v_bfe_u32 v63, v60, 3, 2
    v_and_or_b32 v63, v60, 32, v63
    v_lshl_add_u32 v62, v62, 2, v63
    v_lshl_add_u32 v62, v30, 6, v62
    v_add_u32 v69, 2, v68
    v_lshlrev_b32 v62, 2, v62
    ds_write_b16 v61, v69
    v_add_u32 v62, 100352, v62
    ds_write_b32 v62, v34
    v_and_b32 v60, v11, v51
    v_sad_u8 v60, v60, 0, v47
    v_cmp_lt_u32 vcc, 62, v60
    v_min_u32 v60, 62, v60
    s_or_b64 s[70:71], s[70:71], vcc
    v_cmp_lt_u32 vcc, 30, v60
    v_lshl_add_u32 v61, v31, 6, v60
    v_lshlrev_b32 v61, 1, v61
    v_addc_co_u32 v60, vcc, 0, v60, vcc
    v_add_u32 v61, 133120, v61
    v_and_b32 v62, 7, v60
    v_bfe_u32 v63, v60, 3, 2
    v_and_or_b32 v63, v60, 32, v63
    v_lshl_add_u32 v62, v62, 2, v63
    v_lshl_add_u32 v62, v31, 6, v62
    v_add_u32 v69, 3, v68
    v_lshlrev_b32 v62, 2, v62
    ds_write_b16 v61, v69
    v_add_u32 v62, 100352, v62
    ds_write_b32 v62, v35
    s_mov_b64 exec, s[70:71]
    v_mov_b32 v60, 150528
    ds_write_b32 v60, v20
L_k1_b2:
    s_mov_b64 exec, -1
    s_waitcnt lgkmcnt(0)
    s_barrier
    v_lshrrev_b32 v30, 3, v0
    v_and_b32 v31, 7, v0
    v_lshlrev_b32 v31, 4, v31
    v_lshl_add_u32 v5, v30, 8, v31
    v_add_u32 v5, 100352, v5
    v_lshlrev_b32 v27, 2, v30
    v_add_u32 v27, 149504, v27
    ds_read_b128 v[16:19], v5
    ds_read_b128 v[20:23], v5 offset:128
    ds_read_b32 v27, v27
    v_and_b32 v24, 7, v2
    s_lshl_b32 s57, s3, 5
    v_lshl_add_u32 v24, v24, 2, s57
    v_add_u32 v24, 149504, v24
    ds_read_b32 v26, v24
    v_lshrrev_b32 v28, 1, v2
    s_lshl_b32 s57, s3, 10
    s_add_u32 s57, s57, 133120
    v_lshl_add_u32 v29, v28, 1, s57
    ds_read_u16 v8, v29 offset:0
    ds_read_u16 v9, v29 offset:128
    ds_read_u16 v10, v29 offset:256
    ds_read_u16 v11, v29 offset:384
    ds_read_u16 v12, v29 offset:512
    ds_read_u16 v13, v29 offset:640
    ds_read_u16 v14, v29 offset:768
    ds_read_u16 v15, v29 offset:896
    v_lshl_or_b32 v30, v30, 15, v31
    s_lshl_b32 s58, s2, 8
    v_and_b32 v31, 1, v2
    v_lshlrev_b32 v31, 4, v31
    s_waitcnt lgkmcnt(0)
    buffer_store_dwordx4 v[16:19], v30, s[32:35], s58 offen sc0 sc1
    v_sad_u8 v27, v27, 0, 0
    v_mov_b32 v25, 0x80000000
    v_cmp_lt_u32 vcc, 31, v27
    v_sad_u8 v26, v26, 0, 3
    s_nop 0
    v_cndmask_b32 v30, v25, v30, vcc
    buffer_store_dwordx4 v[20:23], v30, s[32:35], s58 offen offset:128 sc0 sc1
    v_and_b32 v26, -4, v26
    v_min_u32 v26, 64, v26
    s_waitcnt vmcnt(2)
    s_barrier
    v_lshl_add_u32 v8, v8, 5, v31
    ds_read_b128 v[64:67], v8
    v_readlane_b32 s60, v26, 0
    v_lshl_add_u32 v9, v9, 5, v31
    ds_read_b128 v[68:71], v9
    v_readlane_b32 s61, v26, 1
    v_lshl_add_u32 v10, v10, 5, v31
    ds_read_b128 v[72:75], v10
    v_readlane_b32 s62, v26, 2
    v_lshl_add_u32 v11, v11, 5, v31
    ds_read_b128 v[76:79], v11
    v_readlane_b32 s63, v26, 3
    v_lshl_add_u32 v12, v12, 5, v31
    ds_read_b128 v[80:83], v12
    v_readlane_b32 s64, v26, 4
    v_lshl_add_u32 v13, v13, 5, v31
    ds_read_b128 v[84:87], v13
    v_readlane_b32 s65, v26, 5
    v_lshl_add_u32 v14, v14, 5, v31
    ds_read_b128 v[88:91], v14
    v_readlane_b32 s66, v26, 6
    v_lshl_add_u32 v15, v15, 5, v31
    ds_read_b128 v[92:95], v15
    v_readlane_b32 s67, v26, 7
    s_lshl_b32 s57, s3, 21
    s_lshl_b32 s58, s2, 11
    s_add_u32 s57, s57, s58
    v_cmp_gt_u32 vcc, s60, v28
    s_mov_b64 exec, vcc
    s_waitcnt lgkmcnt(7)
    buffer_store_dwordx4 v[64:67], v3, s[36:39], s57 offen sc0 sc1
    s_mov_b64 exec, -1
    s_add_u32 s57, s57, 0x40000
    v_cmp_gt_u32 vcc, s61, v28
    s_mov_b64 exec, vcc
    s_waitcnt lgkmcnt(6)
    buffer_store_dwordx4 v[68:71], v3, s[36:39], s57 offen sc0 sc1
    s_mov_b64 exec, -1
    s_add_u32 s57, s57, 0x40000
    v_cmp_gt_u32 vcc, s62, v28
    s_mov_b64 exec, vcc
    s_waitcnt lgkmcnt(5)
    buffer_store_dwordx4 v[72:75], v3, s[36:39], s57 offen sc0 sc1
    s_mov_b64 exec, -1
    s_add_u32 s57, s57, 0x40000
    v_cmp_gt_u32 vcc, s63, v28
    s_mov_b64 exec, vcc
    s_waitcnt lgkmcnt(4)
    buffer_store_dwordx4 v[76:79], v3, s[36:39], s57 offen sc0 sc1
    s_mov_b64 exec, -1
    s_add_u32 s57, s57, 0x40000
    v_cmp_gt_u32 vcc, s64, v28
    s_mov_b64 exec, vcc
    s_waitcnt lgkmcnt(3)
    buffer_store_dwordx4 v[80:83], v3, s[36:39], s57 offen sc0 sc1
    s_mov_b64 exec, -1
    s_add_u32 s57, s57, 0x40000
    v_cmp_gt_u32 vcc, s65, v28
    s_mov_b64 exec, vcc
    s_waitcnt lgkmcnt(2)
    buffer_store_dwordx4 v[84:87], v3, s[36:39], s57 offen sc0 sc1
    s_mov_b64 exec, -1
    s_add_u32 s57, s57, 0x40000
    v_cmp_gt_u32 vcc, s66, v28
    s_mov_b64 exec, vcc
    s_waitcnt lgkmcnt(1)
    buffer_store_dwordx4 v[88:91], v3, s[36:39], s57 offen sc0 sc1
    s_mov_b64 exec, -1
    s_add_u32 s57, s57, 0x40000
    v_cmp_gt_u32 vcc, s67, v28
    s_mov_b64 exec, vcc
    s_waitcnt lgkmcnt(0)
    buffer_store_dwordx4 v[92:95], v3, s[36:39], s57 offen sc0 sc1
    s_mov_b64 exec, -1
    s_add_u32 s57, s57, 0x40000
    s_sub_u32 s57, s57, 0x200000
    v_add_u32 v32, 32, v28
    s_cmp_le_u32 s60, 32
    s_cbranch_scc1 L_k1long_1
    ds_read_u16 v33, v29 offset:64
    s_waitcnt lgkmcnt(0)
    v_lshl_add_u32 v33, v33, 5, v31
    ds_read_b128 v[36:39], v33
    v_cmp_gt_u32 vcc, s60, v32
    s_mov_b64 exec, vcc
    s_waitcnt lgkmcnt(0)
    buffer_store_dwordx4 v[36:39], v3, s[36:39], s57 offen offset:1024 sc0 sc1
    s_mov_b64 exec, -1
    s_nop 0
L_k1long_1:
    s_add_u32 s57, s57, 0x40000
    s_cmp_le_u32 s61, 32
    s_cbranch_scc1 L_k1long_2
    ds_read_u16 v33, v29 offset:192
    s_waitcnt lgkmcnt(0)
    v_lshl_add_u32 v33, v33, 5, v31
    ds_read_b128 v[36:39], v33
    v_cmp_gt_u32 vcc, s61, v32
    s_mov_b64 exec, vcc
    s_waitcnt lgkmcnt(0)
    buffer_store_dwordx4 v[36:39], v3, s[36:39], s57 offen offset:1024 sc0 sc1
    s_mov_b64 exec, -1
    s_nop 0
L_k1long_2:
    s_add_u32 s57, s57, 0x40000
    s_cmp_le_u32 s62, 32
    s_cbranch_scc1 L_k1long_3
    ds_read_u16 v33, v29 offset:320
    s_waitcnt lgkmcnt(0)
    v_lshl_add_u32 v33, v33, 5, v31
    ds_read_b128 v[36:39], v33
    v_cmp_gt_u32 vcc, s62, v32
    s_mov_b64 exec, vcc
    s_waitcnt lgkmcnt(0)
    buffer_store_dwordx4 v[36:39], v3, s[36:39], s57 offen offset:1024 sc0 sc1
    s_mov_b64 exec, -1
    s_nop 0
L_k1long_3:
    s_add_u32 s57, s57, 0x40000
    s_cmp_le_u32 s63, 32
    s_cbranch_scc1 L_k1long_4
    ds_read_u16 v33, v29 offset:448
    s_waitcnt lgkmcnt(0)
    v_lshl_add_u32 v33, v33, 5, v31
    ds_read_b128 v[36:39], v33
    v_cmp_gt_u32 vcc, s63, v32
    s_mov_b64 exec, vcc
    s_waitcnt lgkmcnt(0)
    buffer_store_dwordx4 v[36:39], v3, s[36:39], s57 offen offset:1024 sc0 sc1
    s_mov_b64 exec, -1
    s_nop 0
L_k1long_4:
    s_add_u32 s57, s57, 0x40000
    s_cmp_le_u32 s64, 32
    s_cbranch_scc1 L_k1long_5
    ds_read_u16 v33, v29 offset:576
    s_waitcnt lgkmcnt(0)
    v_lshl_add_u32 v33, v33, 5, v31
    ds_read_b128 v[36:39], v33
    v_cmp_gt_u32 vcc, s64, v32
    s_mov_b64 exec, vcc
    s_waitcnt lgkmcnt(0)
    buffer_store_dwordx4 v[36:39], v3, s[36:39], s57 offen offset:1024 sc0 sc1
    s_mov_b64 exec, -1
    s_nop 0
L_k1long_5:
    s_add_u32 s57, s57, 0x40000
    s_cmp_le_u32 s65, 32
    s_cbranch_scc1 L_k1long_6
    ds_read_u16 v33, v29 offset:704
    s_waitcnt lgkmcnt(0)
    v_lshl_add_u32 v33, v33, 5, v31
    ds_read_b128 v[36:39], v33
    v_cmp_gt_u32 vcc, s65, v32
    s_mov_b64 exec, vcc
    s_waitcnt lgkmcnt(0)
    buffer_store_dwordx4 v[36:39], v3, s[36:39], s57 offen offset:1024 sc0 sc1
    s_mov_b64 exec, -1
    s_nop 0
L_k1long_6:
    s_add_u32 s57, s57, 0x40000
    s_cmp_le_u32 s66, 32
    s_cbranch_scc1 L_k1long_7
    ds_read_u16 v33, v29 offset:832
    s_waitcnt lgkmcnt(0)
    v_lshl_add_u32 v33, v33, 5, v31
    ds_read_b128 v[36:39], v33
    v_cmp_gt_u32 vcc, s66, v32
    s_mov_b64 exec, vcc
    s_waitcnt lgkmcnt(0)
    buffer_store_dwordx4 v[36:39], v3, s[36:39], s57 offen offset:1024 sc0 sc1
    s_mov_b64 exec, -1
    s_nop 0
L_k1long_7:
    s_add_u32 s57, s57, 0x40000
    s_cmp_le_u32 s67, 32
    s_cbranch_scc1 L_k1long_8
    ds_read_u16 v33, v29 offset:960
    s_waitcnt lgkmcnt(0)
    v_lshl_add_u32 v33, v33, 5, v31
    ds_read_b128 v[36:39], v33
    v_cmp_gt_u32 vcc, s67, v32
    s_mov_b64 exec, vcc
    s_waitcnt lgkmcnt(0)
    buffer_store_dwordx4 v[36:39], v3, s[36:39], s57 offen offset:1024 sc0 sc1
    s_mov_b64 exec, -1
    s_nop 0
L_k1long_8:
    s_add_u32 s57, s57, 0x40000
    s_mov_b32 s72, s3
    s_mov_b32 s73, 8
    s_branch L_walk0
L_k1_gemm:
    s_mov_b32 s20, s4
    s_mov_b32 s21, s5
    s_mov_b32 s22, 0x61a800
    s_mov_b32 s23, 0x20000
    s_mov_b32 s24, s16
    s_mov_b32 s25, s17
    s_mov_b32 s26, 0x11000
    s_mov_b32 s27, 0x20000
    s_mov_b32 s28, s14
    s_mov_b32 s29, s15
    s_mov_b32 s30, 0x8000
    s_mov_b32 s31, 0x20000
    s_mov_b32 s32, s12
    s_mov_b32 s33, s13
    s_mov_b32 s34, 0x8000
    s_mov_b32 s35, 0x20000
    s_mov_b32 s36, s18
    s_mov_b32 s37, s19
    s_mov_b32 s38, 0x620000
    s_mov_b32 s39, 0x20000
    s_add_u32 s40, s18, 0x620000
    s_addc_u32 s41, s19, 0
    s_mov_b32 s42, 0x620000
    s_mov_b32 s43, 0x20000
    s_sub_u32 s50, s2, 128
    s_lshr_b32 s51, s50, 3
    s_lshl_b32 s52, s3, 4
    s_add_u32 s51, s51, s52
    s_cmp_lt_u32 s51, 196
    s_cselect_b32 s52, 0, 0x10000
    s_add_u32 s51, s51, s52
    s_and_b32 s52, s2, 3
    s_mul_i32 s52, s52, 392
    s_add_u32 s51, s51, s52
    s_bfe_u32 s52, s2, 0x10002
    s_mul_i32 s52, s52, 196
    s_add_u32 s51, s51, s52
    v_mov_b32 v6, 0
    v_mov_b32 v7, 150528
    ds_write_b32 v7, v6
    s_cmp_ge_u32 s51, 1568
    s_cbranch_scc1 L_k1_nox
    s_lshl_b32 s52, s51, 12
    v_bfe_u32 v5, v2, 2, 2
    v_and_b32 v6, 3, v2
    v_lshlrev_b32 v5, 10, v5
    v_lshl_or_b32 v5, v6, 4, v5
    v_lshrrev_b32 v6, 4, v2
    v_lshl_or_b32 v5, v6, 6, v5
    buffer_load_dwordx4 v[8:11], v5, s[20:23], s52 offen offset:0
    buffer_load_dwordx4 v[12:15], v5, s[20:23], s52 offen offset:256
    buffer_load_dwordx4 v[16:19], v5, s[20:23], s52 offen offset:512
    buffer_load_dwordx4 v[20:23], v5, s[20:23], s52 offen offset:768
L_k1_nox:
    s_mov_b32 s53, 32768
    s_mov_b32 s54, 49152
    s_mov_b32 s55, 16384
    buffer_load_dwordx4 v[24:27], v4, s[24:27], s53 offen
    buffer_load_dwordx4 v[28:31], v4, s[24:27], s54 offen
    buffer_load_dwordx4 v[32:35], v4, s[28:31], 0 offen
    buffer_load_dwordx4 v[36:39], v4, s[28:31], s55 offen
    v_lshrrev_b32 v5, 4, v0
    v_lshrrev_b32 v6, 9, v0
    v_mul_u32_u24 v5, 544, v5
    v_lshl_add_u32 v5, v6, 7, v5
    v_bfe_u32 v6, v0, 3, 1
    v_lshl_add_u32 v5, v6, 7, v5
    v_and_b32 v6, 7, v0
    v_lshl_add_u32 v5, v6, 2, v5
    s_mov_b32 s56, 0x05040100
    s_mov_b32 s57, 0x07060302
    s_cmp_lg_u32 s3, 15
    s_cbranch_scc1 L_k1_noimg
    s_cmp_ge_u32 s50, 72
    s_cbranch_scc1 L_k1_noimg
    v_and_b32 v6, 15, v2
    v_lshrrev_b32 v7, 4, v2
    v_lshlrev_b32 v6, 3, v6
    s_cmp_ge_u32 s50, 64
    s_cbranch_scc1 L_k1_cimg
    s_bfe_u32 s58, s50, 0x10005
    s_bfe_u32 s59, s50, 0x20002
    s_and_b32 s60, s50, 3
    s_lshl_b32 s58, s58, 7
    s_lshl_b32 s59, s59, 1
    s_lshl_b32 s60, s60, 11
    s_add_u32 s58, s58, s59
    s_add_u32 s58, s58, s60
    v_lshl_add_u32 v6, v7, 13, v6
    s_bitcmp1_b32 s50, 4
    s_cbranch_scc1 L_k1_uimg
    buffer_load_ushort v64, v6, s[24:27], s58 offen offset:0
    buffer_load_ushort v65, v6, s[24:27], s58 offen offset:256
    buffer_load_ushort v66, v6, s[24:27], s58 offen offset:512
    buffer_load_ushort v67, v6, s[24:27], s58 offen offset:768
    buffer_load_ushort v68, v6, s[24:27], s58 offen offset:1024
    buffer_load_ushort v69, v6, s[24:27], s58 offen offset:1280
    buffer_load_ushort v70, v6, s[24:27], s58 offen offset:1536
    buffer_load_ushort v71, v6, s[24:27], s58 offen offset:1792
    s_branch L_k1_imgst
L_k1_uimg:
    buffer_load_ushort v64, v6, s[32:35], s58 offen offset:0
    buffer_load_ushort v65, v6, s[32:35], s58 offen offset:256
    buffer_load_ushort v66, v6, s[32:35], s58 offen offset:512
    buffer_load_ushort v67, v6, s[32:35], s58 offen offset:768
    buffer_load_ushort v68, v6, s[32:35], s58 offen offset:1024
    buffer_load_ushort v69, v6, s[32:35], s58 offen offset:1280
    buffer_load_ushort v70, v6, s[32:35], s58 offen offset:1536
    buffer_load_ushort v71, v6, s[32:35], s58 offen offset:1792
L_k1_imgst:
    s_and_b32 s58, s50, 31
    s_lshl_b32 s58, s58, 10
    s_lshr_b32 s59, s50, 5
    s_mul_i32 s59, s59, 36864
    s_add_u32 s58, s58, s59
    s_waitcnt vmcnt(0)
    v_lshl_or_b32 v56, v65, 16, v64
    v_lshl_or_b32 v57, v67, 16, v66
    v_lshl_or_b32 v58, v69, 16, v68
    v_lshl_or_b32 v59, v71, 16, v70
    buffer_store_dwordx4 v[56:59], v3, s[44:47], s58 offen
    s_branch L_k1_noimg
L_k1_cimg:
    s_sub_u32 s61, s50, 64
    s_lshr_b32 s58, s61, 2
    s_and_b32 s59, s61, 3
    s_lshl_b32 s58, s58, 7
    s_lshl_b32 s59, s59, 1
    s_add_u32 s58, s58, s59
    s_add_u32 s58, s58, 65536
    v_lshl_add_u32 v6, v7, 10, v6
    buffer_load_ushort v56, v6, s[24:27], s58 offen offset:0
    buffer_load_ushort v57, v6, s[24:27], s58 offen offset:256
    buffer_load_ushort v58, v6, s[24:27], s58 offen offset:512
    buffer_load_ushort v59, v6, s[24:27], s58 offen offset:768
    s_mov_b32 s59, 0xbfb8aa3b
    s_and_b32 s58, s61, 3
    s_lshl_b32 s58, s58, 9
    s_lshr_b32 s60, s61, 2
    s_mul_i32 s60, s60, 36864
    s_add_u32 s58, s58, s60
    s_add_u32 s58, s58, 32768
    v_lshlrev_b32 v7, 3, v2
    s_waitcnt vmcnt(0)
    v_lshlrev_b32 v56, 16, v56
    v_mul_f32 v56, s59, v56
    v_lshlrev_b32 v57, 16, v57
    v_mul_f32 v57, s59, v57
    v_lshlrev_b32 v58, 16, v58
    v_mul_f32 v58, s59, v58
    v_lshlrev_b32 v59, 16, v59
    v_mul_f32 v59, s59, v59
    v_cvt_pk_bf16_f32 v56, v56, v57
    v_cvt_pk_bf16_f32 v57, v58, v59
    buffer_store_dwordx2 v[56:57], v7, s[44:47], s58 offen
L_k1_noimg:
    s_waitcnt vmcnt(3)
    v_perm_b32 v60, v26, v24, s56
    v_perm_b32 v61, v26, v24, s57
    v_perm_b32 v62, v27, v25, s56
    v_perm_b32 v63, v27, v25, s57
    ds_write_b32 v5, v60 offset:0
    ds_write_b32 v5, v61 offset:32
    ds_write_b32 v5, v62 offset:64
    ds_write_b32 v5, v63 offset:96
    s_waitcnt vmcnt(2)
    v_perm_b32 v60, v30, v28, s56
    v_perm_b32 v61, v30, v28, s57
    v_perm_b32 v62, v31, v29, s56
    v_perm_b32 v63, v31, v29, s57
    ds_write_b32 v5, v60 offset:35072
    ds_write_b32 v5, v61 offset:35104
    ds_write_b32 v5, v62 offset:35136
    ds_write_b32 v5, v63 offset:35168
    s_waitcnt vmcnt(1)
    v_perm_b32 v60, v34, v32, s56
    v_perm_b32 v61, v34, v32, s57
    v_perm_b32 v62, v35, v33, s56
    v_perm_b32 v63, v35, v33, s57
    ds_write_b32 v5, v60 offset:256
    ds_write_b32 v5, v61 offset:288
    ds_write_b32 v5, v62 offset:320
    ds_write_b32 v5, v63 offset:352
    s_waitcnt vmcnt(0)
    v_perm_b32 v60, v38, v36, s56
    v_perm_b32 v61, v38, v36, s57
    v_perm_b32 v62, v39, v37, s56
    v_perm_b32 v63, v39, v37, s57
    ds_write_b32 v5, v60 offset:35328
    ds_write_b32 v5, v61 offset:35360
    ds_write_b32 v5, v62 offset:35392
    ds_write_b32 v5, v63 offset:35424
    v_and_b32 v6, 15, v2
    v_lshrrev_b32 v7, 4, v2
    s_cmp_ge_u32 s51, 1568
    s_cbranch_scc1 L_k1_nobp
    s_mov_b32 vcc_lo, 0x55555555
    s_mov_b32 vcc_hi, 0x55555555
    v_cndmask_b32_dpp v24, v12, v8, vcc quad_perm:[1,0,3,2] row_mask:0xf bank_mask:0xf
    v_cndmask_b32_dpp v25, v13, v9, vcc quad_perm:[1,0,3,2] row_mask:0xf bank_mask:0xf
    v_cndmask_b32_dpp v26, v14, v10, vcc quad_perm:[1,0,3,2] row_mask:0xf bank_mask:0xf
    v_cndmask_b32_dpp v27, v15, v11, vcc quad_perm:[1,0,3,2] row_mask:0xf bank_mask:0xf
    v_cndmask_b32_dpp v32, v20, v16, vcc quad_perm:[1,0,3,2] row_mask:0xf bank_mask:0xf
    v_cndmask_b32_dpp v33, v21, v17, vcc quad_perm:[1,0,3,2] row_mask:0xf bank_mask:0xf
    v_cndmask_b32_dpp v34, v22, v18, vcc quad_perm:[1,0,3,2] row_mask:0xf bank_mask:0xf
    v_cndmask_b32_dpp v35, v23, v19, vcc quad_perm:[1,0,3,2] row_mask:0xf bank_mask:0xf
    s_mov_b32 vcc_lo, 0xaaaaaaaa
    s_mov_b32 vcc_hi, 0xaaaaaaaa
    v_cndmask_b32_dpp v28, v8, v12, vcc quad_perm:[1,0,3,2] row_mask:0xf bank_mask:0xf
    v_cndmask_b32_dpp v29, v9, v13, vcc quad_perm:[1,0,3,2] row_mask:0xf bank_mask:0xf
    v_cndmask_b32_dpp v30, v10, v14, vcc quad_perm:[1,0,3,2] row_mask:0xf bank_mask:0xf
    v_cndmask_b32_dpp v31, v11, v15, vcc quad_perm:[1,0,3,2] row_mask:0xf bank_mask:0xf
    v_cndmask_b32_dpp v36, v16, v20, vcc quad_perm:[1,0,3,2] row_mask:0xf bank_mask:0xf
    v_cndmask_b32_dpp v37, v17, v21, vcc quad_perm:[1,0,3,2] row_mask:0xf bank_mask:0xf
    v_cndmask_b32_dpp v38, v18, v22, vcc quad_perm:[1,0,3,2] row_mask:0xf bank_mask:0xf
    v_cndmask_b32_dpp v39, v19, v23, vcc quad_perm:[1,0,3,2] row_mask:0xf bank_mask:0xf
    s_mov_b32 vcc_lo, 0x33333333
    s_mov_b32 vcc_hi, 0x33333333
    v_cndmask_b32_dpp v40, v32, v24, vcc quad_perm:[2,3,0,1] row_mask:0xf bank_mask:0xf
    v_cndmask_b32_dpp v41, v33, v25, vcc quad_perm:[2,3,0,1] row_mask:0xf bank_mask:0xf
    v_cndmask_b32_dpp v42, v34, v26, vcc quad_perm:[2,3,0,1] row_mask:0xf bank_mask:0xf
    v_cndmask_b32_dpp v43, v35, v27, vcc quad_perm:[2,3,0,1] row_mask:0xf bank_mask:0xf
    v_cndmask_b32_dpp v44, v36, v28, vcc quad_perm:[2,3,0,1] row_mask:0xf bank_mask:0xf
    v_cndmask_b32_dpp v45, v37, v29, vcc quad_perm:[2,3,0,1] row_mask:0xf bank_mask:0xf
    v_cndmask_b32_dpp v46, v38, v30, vcc quad_perm:[2,3,0,1] row_mask:0xf bank_mask:0xf
    v_cndmask_b32_dpp v47, v39, v31, vcc quad_perm:[2,3,0,1] row_mask:0xf bank_mask:0xf
    s_mov_b32 vcc_lo, 0xcccccccc
    s_mov_b32 vcc_hi, 0xcccccccc
    v_cndmask_b32_dpp v48, v24, v32, vcc quad_perm:[2,3,0,1] row_mask:0xf bank_mask:0xf
    v_cndmask_b32_dpp v49, v25, v33, vcc quad_perm:[2,3,0,1] row_mask:0xf bank_mask:0xf
    v_cndmask_b32_dpp v50, v26, v34, vcc quad_perm:[2,3,0,1] row_mask:0xf bank_mask:0xf
    v_cndmask_b32_dpp v51, v27, v35, vcc quad_perm:[2,3,0,1] row_mask:0xf bank_mask:0xf
    v_cndmask_b32_dpp v52, v28, v36, vcc quad_perm:[2,3,0,1] row_mask:0xf bank_mask:0xf
    v_cndmask_b32_dpp v53, v29, v37, vcc quad_perm:[2,3,0,1] row_mask:0xf bank_mask:0xf
    v_cndmask_b32_dpp v54, v30, v38, vcc quad_perm:[2,3,0,1] row_mask:0xf bank_mask:0xf
    v_cndmask_b32_dpp v55, v31, v39, vcc quad_perm:[2,3,0,1] row_mask:0xf bank_mask:0xf
L_k1_nobp:
    v_bfe_u32 v61, v2, 2, 2
    v_lshl_add_u32 v61, v7, 5, v61
    v_mul_u32_u24 v61, 544, v61
    v_lshl_add_u32 v61, v7, 7, v61
    v_and_b32 v62, 3, v2
    v_lshl_add_u32 v5, v62, 3, v61
    s_waitcnt lgkmcnt(0)
    s_barrier
    s_sub_u32 s72, s3, 13
    s_mov_b32 s73, 3
    s_cmp_ge_u32 s3, 13
    s_cbranch_scc1 L_walk0
    s_cmp_ge_u32 s51, 1568
    s_cbranch_scc1 L_k1_gdone
    ds_read_b64_tr_b16 v[8:9], v5 offset:0
    ds_read_b64_tr_b16 v[10:11], v5 offset:2176
    ds_read_b64_tr_b16 v[12:13], v5 offset:4352
    ds_read_b64_tr_b16 v[14:15], v5 offset:6528
    ds_read_b64_tr_b16 v[16:17], v5 offset:8704
    ds_read_b64_tr_b16 v[18:19], v5 offset:10880
    ds_read_b64_tr_b16 v[20:21], v5 offset:13056
    ds_read_b64_tr_b16 v[22:23], v5 offset:15232
    ds_read_b64_tr_b16 v[24:25], v5 offset:256
    ds_read_b64_tr_b16 v[26:27], v5 offset:2432
    ds_read_b64_tr_b16 v[28:29], v5 offset:4608
    ds_read_b64_tr_b16 v[30:31], v5 offset:6784
    s_waitcnt lgkmcnt(10)
    v_mfma_f32_16x16x32_bf16 v[56:59], v[40:43], v[8:11], 0
    ds_read_b64_tr_b16 v[32:33], v5 offset:8960
    ds_read_b64_tr_b16 v[34:35], v5 offset:11136
    s_waitcnt lgkmcnt(10)
    v_mfma_f32_16x16x32_bf16 v[56:59], v[44:47], v[12:15], v[56:59]
    ds_read_b64_tr_b16 v[36:37], v5 offset:13312
    ds_read_b64_tr_b16 v[38:39], v5 offset:15488
    s_waitcnt lgkmcnt(10)
    v_mfma_f32_16x16x32_bf16 v[56:59], v[48:51], v[16:19], v[56:59]
    ds_read_b64_tr_b16 v[8:9], v5 offset:32
    ds_read_b64_tr_b16 v[10:11], v5 offset:2208
    s_waitcnt lgkmcnt(10)
    v_mfma_f32_16x16x32_bf16 v[56:59], v[52:55], v[20:23], v[56:59]
    ds_read_b64_tr_b16 v[12:13], v5 offset:4384
    ds_read_b64_tr_b16 v[14:15], v5 offset:6560
    s_waitcnt lgkmcnt(10)
    v_mfma_f32_16x16x32_bf16 v[60:63], v[40:43], v[24:27], 0
    ds_read_b64_tr_b16 v[16:17], v5 offset:8736
    ds_read_b64_tr_b16 v[18:19], v5 offset:10912
    s_waitcnt lgkmcnt(10)
    v_mfma_f32_16x16x32_bf16 v[60:63], v[44:47], v[28:31], v[60:63]
    ds_read_b64_tr_b16 v[20:21], v5 offset:13088
    ds_read_b64_tr_b16 v[22:23], v5 offset:15264
    s_waitcnt lgkmcnt(10)
    v_mfma_f32_16x16x32_bf16 v[60:63], v[48:51], v[32:35], v[60:63]
    ds_read_b64_tr_b16 v[24:25], v5 offset:288
    ds_read_b64_tr_b16 v[26:27], v5 offset:2464
    s_waitcnt lgkmcnt(10)
    v_mfma_f32_16x16x32_bf16 v[60:63], v[52:55], v[36:39], v[60:63]
    ds_read_b64_tr_b16 v[28:29], v5 offset:4640
    ds_read_b64_tr_b16 v[30:31], v5 offset:6816
    s_waitcnt lgkmcnt(10)
    v_mfma_f32_16x16x32_bf16 v[64:67], v[40:43], v[8:11], 0
    ds_read_b64_tr_b16 v[32:33], v5 offset:8992
    ds_read_b64_tr_b16 v[34:35], v5 offset:11168
    s_waitcnt lgkmcnt(10)
    v_mfma_f32_16x16x32_bf16 v[64:67], v[44:47], v[12:15], v[64:67]
    ds_read_b64_tr_b16 v[36:37], v5 offset:13344
    ds_read_b64_tr_b16 v[38:39], v5 offset:15520
    s_waitcnt lgkmcnt(10)
    v_mfma_f32_16x16x32_bf16 v[64:67], v[48:51], v[16:19], v[64:67]
    ds_read_b64_tr_b16 v[8:9], v5 offset:64
    ds_read_b64_tr_b16 v[10:11], v5 offset:2240
    s_waitcnt lgkmcnt(10)
    v_mfma_f32_16x16x32_bf16 v[64:67], v[52:55], v[20:23], v[64:67]
    ds_read_b64_tr_b16 v[12:13], v5 offset:4416
    ds_read_b64_tr_b16 v[14:15], v5 offset:6592
    s_waitcnt lgkmcnt(10)
    v_mfma_f32_16x16x32_bf16 v[68:71], v[40:43], v[24:27], 0
    ds_read_b64_tr_b16 v[16:17], v5 offset:8768
    ds_read_b64_tr_b16 v[18:19], v5 offset:10944
    s_waitcnt lgkmcnt(10)
    v_mfma_f32_16x16x32_bf16 v[68:71], v[44:47], v[28:31], v[68:71]
    ds_read_b64_tr_b16 v[20:21], v5 offset:13120
    ds_read_b64_tr_b16 v[22:23], v5 offset:15296
    s_waitcnt lgkmcnt(10)
    v_mfma_f32_16x16x32_bf16 v[68:71], v[48:51], v[32:35], v[68:71]
    ds_read_b64_tr_b16 v[24:25], v5 offset:320
    ds_read_b64_tr_b16 v[26:27], v5 offset:2496
    s_waitcnt lgkmcnt(10)
    v_mfma_f32_16x16x32_bf16 v[68:71], v[52:55], v[36:39], v[68:71]
    ds_read_b64_tr_b16 v[28:29], v5 offset:4672
    ds_read_b64_tr_b16 v[30:31], v5 offset:6848
    s_waitcnt lgkmcnt(10)
    v_mfma_f32_16x16x32_bf16 v[72:75], v[40:43], v[8:11], 0
    ds_read_b64_tr_b16 v[32:33], v5 offset:9024
    ds_read_b64_tr_b16 v[34:35], v5 offset:11200
    s_waitcnt lgkmcnt(10)
    v_mfma_f32_16x16x32_bf16 v[72:75], v[44:47], v[12:15], v[72:75]
    ds_read_b64_tr_b16 v[36:37], v5 offset:13376
    ds_read_b64_tr_b16 v[38:39], v5 offset:15552
    s_waitcnt lgkmcnt(10)
    v_mfma_f32_16x16x32_bf16 v[72:75], v[48:51], v[16:19], v[72:75]
    ds_read_b64_tr_b16 v[8:9], v5 offset:96
    ds_read_b64_tr_b16 v[10:11], v5 offset:2272
    s_waitcnt lgkmcnt(10)
    v_mfma_f32_16x16x32_bf16 v[72:75], v[52:55], v[20:23], v[72:75]
    ds_read_b64_tr_b16 v[12:13], v5 offset:4448
    ds_read_b64_tr_b16 v[14:15], v5 offset:6624
    s_waitcnt lgkmcnt(10)
    v_mfma_f32_16x16x32_bf16 v[76:79], v[40:43], v[24:27], 0
    ds_read_b64_tr_b16 v[16:17], v5 offset:8800
    ds_read_b64_tr_b16 v[18:19], v5 offset:10976
    s_waitcnt lgkmcnt(10)
    v_mfma_f32_16x16x32_bf16 v[76:79], v[44:47], v[28:31], v[76:79]
    ds_read_b64_tr_b16 v[20:21], v5 offset:13152
    ds_read_b64_tr_b16 v[22:23], v5 offset:15328
    s_waitcnt lgkmcnt(10)
    v_mfma_f32_16x16x32_bf16 v[76:79], v[48:51], v[32:35], v[76:79]
    ds_read_b64_tr_b16 v[24:25], v5 offset:352
    ds_read_b64_tr_b16 v[26:27], v5 offset:2528
    s_waitcnt lgkmcnt(10)
    v_mfma_f32_16x16x32_bf16 v[76:79], v[52:55], v[36:39], v[76:79]
    ds_read_b64_tr_b16 v[28:29], v5 offset:4704
    ds_read_b64_tr_b16 v[30:31], v5 offset:6880
    s_waitcnt lgkmcnt(10)
    v_mfma_f32_16x16x32_bf16 v[80:83], v[40:43], v[8:11], 0
    ds_read_b64_tr_b16 v[32:33], v5 offset:9056
    ds_read_b64_tr_b16 v[34:35], v5 offset:11232
    s_waitcnt lgkmcnt(10)
    v_mfma_f32_16x16x32_bf16 v[80:83], v[44:47], v[12:15], v[80:83]
    ds_read_b64_tr_b16 v[36:37], v5 offset:13408
    ds_read_b64_tr_b16 v[38:39], v5 offset:15584
    s_waitcnt lgkmcnt(10)
    v_mfma_f32_16x16x32_bf16 v[80:83], v[48:51], v[16:19], v[80:83]
    ds_read_b64_tr_b16 v[8:9], v5 offset:128
    ds_read_b64_tr_b16 v[10:11], v5 offset:2304
    s_waitcnt lgkmcnt(10)
    v_mfma_f32_16x16x32_bf16 v[80:83], v[52:55], v[20:23], v[80:83]
    ds_read_b64_tr_b16 v[12:13], v5 offset:4480
    ds_read_b64_tr_b16 v[14:15], v5 offset:6656
    s_waitcnt lgkmcnt(10)
    v_mfma_f32_16x16x32_bf16 v[84:87], v[40:43], v[24:27], 0
    ds_read_b64_tr_b16 v[16:17], v5 offset:8832
    ds_read_b64_tr_b16 v[18:19], v5 offset:11008
    s_waitcnt lgkmcnt(10)
    v_mfma_f32_16x16x32_bf16 v[84:87], v[44:47], v[28:31], v[84:87]
    ds_read_b64_tr_b16 v[20:21], v5 offset:13184
    ds_read_b64_tr_b16 v[22:23], v5 offset:15360
    s_waitcnt lgkmcnt(10)
    v_mfma_f32_16x16x32_bf16 v[84:87], v[48:51], v[32:35], v[84:87]
    ds_read_b64_tr_b16 v[24:25], v5 offset:384
    ds_read_b64_tr_b16 v[26:27], v5 offset:2560
    s_waitcnt lgkmcnt(10)
    v_mfma_f32_16x16x32_bf16 v[84:87], v[52:55], v[36:39], v[84:87]
    ds_read_b64_tr_b16 v[28:29], v5 offset:4736
    ds_read_b64_tr_b16 v[30:31], v5 offset:6912
    s_waitcnt lgkmcnt(10)
    v_mfma_f32_16x16x32_bf16 v[88:91], v[40:43], v[8:11], 0
    ds_read_b64_tr_b16 v[32:33], v5 offset:9088
    ds_read_b64_tr_b16 v[34:35], v5 offset:11264
    s_waitcnt lgkmcnt(10)
    v_mfma_f32_16x16x32_bf16 v[88:91], v[44:47], v[12:15], v[88:91]
    ds_read_b64_tr_b16 v[36:37], v5 offset:13440
    ds_read_b64_tr_b16 v[38:39], v5 offset:15616
    s_waitcnt lgkmcnt(10)
    v_mfma_f32_16x16x32_bf16 v[88:91], v[48:51], v[16:19], v[88:91]
    ds_read_b64_tr_b16 v[8:9], v5 offset:160
    ds_read_b64_tr_b16 v[10:11], v5 offset:2336
    s_waitcnt lgkmcnt(10)
    v_mfma_f32_16x16x32_bf16 v[88:91], v[52:55], v[20:23], v[88:91]
    ds_read_b64_tr_b16 v[12:13], v5 offset:4512
    ds_read_b64_tr_b16 v[14:15], v5 offset:6688
    s_waitcnt lgkmcnt(10)
    v_mfma_f32_16x16x32_bf16 v[92:95], v[40:43], v[24:27], 0
    ds_read_b64_tr_b16 v[16:17], v5 offset:8864
    ds_read_b64_tr_b16 v[18:19], v5 offset:11040
    s_waitcnt lgkmcnt(10)
    v_mfma_f32_16x16x32_bf16 v[92:95], v[44:47], v[28:31], v[92:95]
    ds_read_b64_tr_b16 v[20:21], v5 offset:13216
    ds_read_b64_tr_b16 v[22:23], v5 offset:15392
    s_waitcnt lgkmcnt(10)
    v_mfma_f32_16x16x32_bf16 v[92:95], v[48:51], v[32:35], v[92:95]
    ds_read_b64_tr_b16 v[24:25], v5 offset:416
    ds_read_b64_tr_b16 v[26:27], v5 offset:2592
    s_waitcnt lgkmcnt(10)
    v_mfma_f32_16x16x32_bf16 v[92:95], v[52:55], v[36:39], v[92:95]
    ds_read_b64_tr_b16 v[28:29], v5 offset:4768
    ds_read_b64_tr_b16 v[30:31], v5 offset:6944
    s_waitcnt lgkmcnt(10)
    v_mfma_f32_16x16x32_bf16 v[96:99], v[40:43], v[8:11], 0
    ds_read_b64_tr_b16 v[32:33], v5 offset:9120
    ds_read_b64_tr_b16 v[34:35], v5 offset:11296
    s_waitcnt lgkmcnt(10)
    v_mfma_f32_16x16x32_bf16 v[96:99], v[44:47], v[12:15], v[96:99]
    ds_read_b64_tr_b16 v[36:37], v5 offset:13472
    ds_read_b64_tr_b16 v[38:39], v5 offset:15648
    s_waitcnt lgkmcnt(10)
    v_mfma_f32_16x16x32_bf16 v[96:99], v[48:51], v[16:19], v[96:99]
    ds_read_b64_tr_b16 v[8:9], v5 offset:192
    ds_read_b64_tr_b16 v[10:11], v5 offset:2368
    s_waitcnt lgkmcnt(10)
    v_mfma_f32_16x16x32_bf16 v[96:99], v[52:55], v[20:23], v[96:99]
    ds_read_b64_tr_b16 v[12:13], v5 offset:4544
    ds_read_b64_tr_b16 v[14:15], v5 offset:6720
    s_waitcnt lgkmcnt(10)
    v_mfma_f32_16x16x32_bf16 v[100:103], v[40:43], v[24:27], 0
    ds_read_b64_tr_b16 v[16:17], v5 offset:8896
    ds_read_b64_tr_b16 v[18:19], v5 offset:11072
    s_waitcnt lgkmcnt(10)
    v_mfma_f32_16x16x32_bf16 v[100:103], v[44:47], v[28:31], v[100:103]
    ds_read_b64_tr_b16 v[20:21], v5 offset:13248
    ds_read_b64_tr_b16 v[22:23], v5 offset:15424
    s_waitcnt lgkmcnt(10)
    v_mfma_f32_16x16x32_bf16 v[100:103], v[48:51], v[32:35], v[100:103]
    ds_read_b64_tr_b16 v[24:25], v5 offset:448
    ds_read_b64_tr_b16 v[26:27], v5 offset:2624
    s_waitcnt lgkmcnt(10)
    v_mfma_f32_16x16x32_bf16 v[100:103], v[52:55], v[36:39], v[100:103]
    ds_read_b64_tr_b16 v[28:29], v5 offset:4800
    ds_read_b64_tr_b16 v[30:31], v5 offset:6976
    s_waitcnt lgkmcnt(10)
    v_mfma_f32_16x16x32_bf16 v[104:107], v[40:43], v[8:11], 0
    ds_read_b64_tr_b16 v[32:33], v5 offset:9152
    ds_read_b64_tr_b16 v[34:35], v5 offset:11328
    s_waitcnt lgkmcnt(10)
    v_mfma_f32_16x16x32_bf16 v[104:107], v[44:47], v[12:15], v[104:107]
    ds_read_b64_tr_b16 v[36:37], v5 offset:13504
    ds_read_b64_tr_b16 v[38:39], v5 offset:15680
    s_waitcnt lgkmcnt(10)
    v_mfma_f32_16x16x32_bf16 v[104:107], v[48:51], v[16:19], v[104:107]
    ds_read_b64_tr_b16 v[8:9], v5 offset:224
    ds_read_b64_tr_b16 v[10:11], v5 offset:2400
    s_waitcnt lgkmcnt(10)
    v_mfma_f32_16x16x32_bf16 v[104:107], v[52:55], v[20:23], v[104:107]
    ds_read_b64_tr_b16 v[12:13], v5 offset:4576
    ds_read_b64_tr_b16 v[14:15], v5 offset:6752
    s_waitcnt lgkmcnt(10)
    v_mfma_f32_16x16x32_bf16 v[108:111], v[40:43], v[24:27], 0
    ds_read_b64_tr_b16 v[16:17], v5 offset:8928
    ds_read_b64_tr_b16 v[18:19], v5 offset:11104
    s_waitcnt lgkmcnt(10)
    v_mfma_f32_16x16x32_bf16 v[108:111], v[44:47], v[28:31], v[108:111]
    ds_read_b64_tr_b16 v[20:21], v5 offset:13280
    ds_read_b64_tr_b16 v[22:23], v5 offset:15456
    s_waitcnt lgkmcnt(10)
    v_mfma_f32_16x16x32_bf16 v[108:111], v[48:51], v[32:35], v[108:111]
    ds_read_b64_tr_b16 v[24:25], v5 offset:480
    ds_read_b64_tr_b16 v[26:27], v5 offset:2656
    s_waitcnt lgkmcnt(10)
    v_mfma_f32_16x16x32_bf16 v[108:111], v[52:55], v[36:39], v[108:111]
    ds_read_b64_tr_b16 v[28:29], v5 offset:4832
    ds_read_b64_tr_b16 v[30:31], v5 offset:7008
    s_waitcnt lgkmcnt(10)
    v_mfma_f32_16x16x32_bf16 v[112:115], v[40:43], v[8:11], 0
    ds_read_b64_tr_b16 v[32:33], v5 offset:9184
    ds_read_b64_tr_b16 v[34:35], v5 offset:11360
    s_waitcnt lgkmcnt(10)
    v_mfma_f32_16x16x32_bf16 v[112:115], v[44:47], v[12:15], v[112:115]
    ds_read_b64_tr_b16 v[36:37], v5 offset:13536
    ds_read_b64_tr_b16 v[38:39], v5 offset:15712
    s_waitcnt lgkmcnt(10)
    v_mfma_f32_16x16x32_bf16 v[112:115], v[48:51], v[16:19], v[112:115]
    s_waitcnt lgkmcnt(8)
    v_mfma_f32_16x16x32_bf16 v[112:115], v[52:55], v[20:23], v[112:115]
    s_waitcnt lgkmcnt(6)
    v_mfma_f32_16x16x32_bf16 v[116:119], v[40:43], v[24:27], 0
    s_waitcnt lgkmcnt(4)
    v_mfma_f32_16x16x32_bf16 v[116:119], v[44:47], v[28:31], v[116:119]
    s_waitcnt lgkmcnt(2)
    v_mfma_f32_16x16x32_bf16 v[116:119], v[48:51], v[32:35], v[116:119]
    s_waitcnt lgkmcnt(0)
    v_mfma_f32_16x16x32_bf16 v[116:119], v[52:55], v[36:39], v[116:119]
    v_mov_b32 v8, 0xbfb8aa3b
    v_mov_b32 v9, 0x7fff
    v_mov_b32 v10, 0xffff0000
    v_mov_b32 v11, 0
    v_lshlrev_b32 v12, 10, v7
    v_lshl_or_b32 v12, v6, 4, v12
    s_nop 3
    v_mul_f32 v24, v8, v56
    v_mul_f32 v25, v8, v64
    v_mul_f32 v26, v8, v72
    v_mul_f32 v27, v8, v80
    v_max3_f32 v11, abs(v24), abs(v25), v11
    v_max3_f32 v11, abs(v26), abs(v27), v11
    v_exp_f32 v24, v24
    v_exp_f32 v25, v25
    v_exp_f32 v26, v26
    v_exp_f32 v27, v27
    s_nop 0
    v_cvt_pk_f16_f32 v24, v24, 0
    v_cvt_pk_f16_f32 v25, v25, 0
    v_cvt_pk_f16_f32 v26, v26, 0
    v_cvt_pk_f16_f32 v27, v27, 0
    v_xad_u32 v28, v24, v9, v60
    v_xad_u32 v29, v25, v9, v68
    v_xad_u32 v30, v26, v9, v76
    v_xad_u32 v31, v27, v9, v84
    v_bfi_b32 v16, v10, v28, v24
    v_bfi_b32 v17, v10, v29, v25
    v_bfi_b32 v18, v10, v30, v26
    v_bfi_b32 v19, v10, v31, v27
    buffer_store_dwordx4 v[16:19], v12, s[36:39], s52 offen offset:0 sc0 sc1
    v_mul_f32 v24, v8, v57
    v_mul_f32 v25, v8, v65
    v_mul_f32 v26, v8, v73
    v_mul_f32 v27, v8, v81
    v_max3_f32 v11, abs(v24), abs(v25), v11
    v_max3_f32 v11, abs(v26), abs(v27), v11
    v_exp_f32 v24, v24
    v_exp_f32 v25, v25
    v_exp_f32 v26, v26
    v_exp_f32 v27, v27
    s_nop 0
    v_cvt_pk_f16_f32 v24, v24, 0
    v_cvt_pk_f16_f32 v25, v25, 0
    v_cvt_pk_f16_f32 v26, v26, 0
    v_cvt_pk_f16_f32 v27, v27, 0
    v_xad_u32 v28, v24, v9, v61
    v_xad_u32 v29, v25, v9, v69
    v_xad_u32 v30, v26, v9, v77
    v_xad_u32 v31, v27, v9, v85
    v_bfi_b32 v20, v10, v28, v24
    v_bfi_b32 v21, v10, v29, v25
    v_bfi_b32 v22, v10, v30, v26
    v_bfi_b32 v23, v10, v31, v27
    buffer_store_dwordx4 v[20:23], v12, s[36:39], s52 offen offset:256 sc0 sc1
    v_mul_f32 v24, v8, v58
    v_mul_f32 v25, v8, v66
    v_mul_f32 v26, v8, v74
    v_mul_f32 v27, v8, v82
    v_max3_f32 v11, abs(v24), abs(v25), v11
    v_max3_f32 v11, abs(v26), abs(v27), v11
    v_exp_f32 v24, v24
    v_exp_f32 v25, v25
    v_exp_f32 v26, v26
    v_exp_f32 v27, v27
    s_nop 0
    v_cvt_pk_f16_f32 v24, v24, 0
    v_cvt_pk_f16_f32 v25, v25, 0
    v_cvt_pk_f16_f32 v26, v26, 0
    v_cvt_pk_f16_f32 v27, v27, 0
    v_xad_u32 v28, v24, v9, v62
    v_xad_u32 v29, v25, v9, v70
    v_xad_u32 v30, v26, v9, v78
    v_xad_u32 v31, v27, v9, v86
    v_bfi_b32 v16, v10, v28, v24
    v_bfi_b32 v17, v10, v29, v25
    v_bfi_b32 v18, v10, v30, v26
    v_bfi_b32 v19, v10, v31, v27
    buffer_store_dwordx4 v[16:19], v12, s[36:39], s52 offen offset:512 sc0 sc1
    v_mul_f32 v24, v8, v59
    v_mul_f32 v25, v8, v67
    v_mul_f32 v26, v8, v75
    v_mul_f32 v27, v8, v83
    v_max3_f32 v11, abs(v24), abs(v25), v11
    v_max3_f32 v11, abs(v26), abs(v27), v11
    v_exp_f32 v24, v24
    v_exp_f32 v25, v25
    v_exp_f32 v26, v26
    v_exp_f32 v27, v27
    s_nop 0
    v_cvt_pk_f16_f32 v24, v24, 0
    v_cvt_pk_f16_f32 v25, v25, 0
    v_cvt_pk_f16_f32 v26, v26, 0
    v_cvt_pk_f16_f32 v27, v27, 0
    v_xad_u32 v28, v24, v9, v63
    v_xad_u32 v29, v25, v9, v71
    v_xad_u32 v30, v26, v9, v79
    v_xad_u32 v31, v27, v9, v87
    v_bfi_b32 v20, v10, v28, v24
    v_bfi_b32 v21, v10, v29, v25
    v_bfi_b32 v22, v10, v30, v26
    v_bfi_b32 v23, v10, v31, v27
    buffer_store_dwordx4 v[20:23], v12, s[36:39], s52 offen offset:768 sc0 sc1
    v_mul_f32 v24, v8, v88
    v_mul_f32 v25, v8, v96
    v_mul_f32 v26, v8, v104
    v_mul_f32 v27, v8, v112
    v_max3_f32 v11, abs(v24), abs(v25), v11
    v_max3_f32 v11, abs(v26), abs(v27), v11
    v_exp_f32 v24, v24
    v_exp_f32 v25, v25
    v_exp_f32 v26, v26
    v_exp_f32 v27, v27
    s_nop 0
    v_cvt_pk_f16_f32 v24, v24, 0
    v_cvt_pk_f16_f32 v25, v25, 0
    v_cvt_pk_f16_f32 v26, v26, 0
    v_cvt_pk_f16_f32 v27, v27, 0
    v_xad_u32 v28, v24, v9, v92
    v_xad_u32 v29, v25, v9, v100
    v_xad_u32 v30, v26, v9, v108
    v_xad_u32 v31, v27, v9, v116
    v_bfi_b32 v16, v10, v28, v24
    v_bfi_b32 v17, v10, v29, v25
    v_bfi_b32 v18, v10, v30, v26
    v_bfi_b32 v19, v10, v31, v27
    buffer_store_dwordx4 v[16:19], v12, s[40:43], s52 offen offset:0 sc0 sc1
    v_mul_f32 v24, v8, v89
    v_mul_f32 v25, v8, v97
    v_mul_f32 v26, v8, v105
    v_mul_f32 v27, v8, v113
    v_max3_f32 v11, abs(v24), abs(v25), v11
    v_max3_f32 v11, abs(v26), abs(v27), v11
    v_exp_f32 v24, v24
    v_exp_f32 v25, v25
    v_exp_f32 v26, v26
    v_exp_f32 v27, v27
    s_nop 0
    v_cvt_pk_f16_f32 v24, v24, 0
    v_cvt_pk_f16_f32 v25, v25, 0
    v_cvt_pk_f16_f32 v26, v26, 0
    v_cvt_pk_f16_f32 v27, v27, 0
    v_xad_u32 v28, v24, v9, v93
    v_xad_u32 v29, v25, v9, v101
    v_xad_u32 v30, v26, v9, v109
    v_xad_u32 v31, v27, v9, v117
    v_bfi_b32 v20, v10, v28, v24
    v_bfi_b32 v21, v10, v29, v25
    v_bfi_b32 v22, v10, v30, v26
    v_bfi_b32 v23, v10, v31, v27
    buffer_store_dwordx4 v[20:23], v12, s[40:43], s52 offen offset:256 sc0 sc1
    v_mul_f32 v24, v8, v90
    v_mul_f32 v25, v8, v98
    v_mul_f32 v26, v8, v106
    v_mul_f32 v27, v8, v114
    v_max3_f32 v11, abs(v24), abs(v25), v11
    v_max3_f32 v11, abs(v26), abs(v27), v11
    v_exp_f32 v24, v24
    v_exp_f32 v25, v25
    v_exp_f32 v26, v26
    v_exp_f32 v27, v27
    s_nop 0
    v_cvt_pk_f16_f32 v24, v24, 0
    v_cvt_pk_f16_f32 v25, v25, 0
    v_cvt_pk_f16_f32 v26, v26, 0
    v_cvt_pk_f16_f32 v27, v27, 0
    v_xad_u32 v28, v24, v9, v94
    v_xad_u32 v29, v25, v9, v102
    v_xad_u32 v30, v26, v9, v110
    v_xad_u32 v31, v27, v9, v118
    v_bfi_b32 v16, v10, v28, v24
    v_bfi_b32 v17, v10, v29, v25
    v_bfi_b32 v18, v10, v30, v26
    v_bfi_b32 v19, v10, v31, v27
    buffer_store_dwordx4 v[16:19], v12, s[40:43], s52 offen offset:512 sc0 sc1
    v_mul_f32 v24, v8, v91
    v_mul_f32 v25, v8, v99
    v_mul_f32 v26, v8, v107
    v_mul_f32 v27, v8, v115
    v_max3_f32 v11, abs(v24), abs(v25), v11
    v_max3_f32 v11, abs(v26), abs(v27), v11
    v_exp_f32 v24, v24
    v_exp_f32 v25, v25
    v_exp_f32 v26, v26
    v_exp_f32 v27, v27
    s_nop 0
    v_cvt_pk_f16_f32 v24, v24, 0
    v_cvt_pk_f16_f32 v25, v25, 0
    v_cvt_pk_f16_f32 v26, v26, 0
    v_cvt_pk_f16_f32 v27, v27, 0
    v_xad_u32 v28, v24, v9, v95
    v_xad_u32 v29, v25, v9, v103
    v_xad_u32 v30, v26, v9, v111
    v_xad_u32 v31, v27, v9, v119
    v_bfi_b32 v20, v10, v28, v24
    v_bfi_b32 v21, v10, v29, v25
    v_bfi_b32 v22, v10, v30, v26
    v_bfi_b32 v23, v10, v31, v27
    buffer_store_dwordx4 v[20:23], v12, s[40:43], s52 offen offset:768 sc0 sc1
    v_mov_b32 v13, 0x41600000
    v_mov_b32 v14, 1
    v_mov_b32 v15, 150528
    v_cmp_nle_f32 vcc, v11, v13
    s_mov_b64 exec, vcc
    ds_write_b32 v15, v14
    s_mov_b64 exec, -1
L_k1_gdone:
    s_waitcnt lgkmcnt(0)
    s_barrier
L_k1_flag:
    s_cmp_lg_u32 s3, 0
    s_cbranch_scc1 L_k1_fin
    v_mov_b32 v15, 150528
    ds_read_b32 v14, v15
    s_lshl_b32 s58, s2, 2
    s_add_u32 s58, s58, 73728
    v_mov_b32 v15, 0
    s_mov_b64 exec, 1
    s_waitcnt lgkmcnt(0)
    buffer_store_dword v14, v15, s[44:47], s58 offen
    s_mov_b64 exec, -1
L_k1_fin:
L_k1_end:
    s_endpgm
L_walkn:
    s_add_u32 s72, s72, s73
L_walk0:
    s_mov_b64 exec, 0
    s_cmp_eq_u32 s72, 0
    s_cbranch_scc1 L_isl_0
    s_cmp_eq_u32 s72, 1
    s_cbranch_scc1 L_isl_4
    s_cmp_eq_u32 s72, 2
    s_cbranch_scc1 L_isl_8
    s_cmp_eq_u32 s72, 3
    s_cbranch_scc1 L_isl_12
    s_cmp_eq_u32 s72, 4
    s_cbranch_scc1 L_isl_16
    s_cmp_eq_u32 s72, 5
    s_cbranch_scc1 L_isl_20
    s_cmp_eq_u32 s72, 6
    s_cbranch_scc1 L_isl_24
    s_cmp_eq_u32 s72, 7
    s_cbranch_scc1 L_isl_28
    s_mov_b64 exec, -1
    s_cmp_ge_u32 s2, 128
    s_cbranch_scc1 L_k1_gdone
    s_branch L_k1_flag
.p2align 8
main_kernel:
    s_cmp_ge_u32 s2, 256
    s_cbranch_scc1 L_k2_end
L_isl_0:
    s_cbranch_execz L_isl_1
    s_load_dwordx2 s[18:19], s[0:1], 72
    s_load_dwordx2 s[4:5], s[0:1], 0
    s_load_dwordx2 s[6:7], s[0:1], 56
    v_mov_b32 v65, v0
    v_lshrrev_b32 v1, 6, v0
    v_and_b32 v64, 63, v0
    v_readfirstlane_b32 s3, v1
    v_lshlrev_b32 v66, 4, v64
    v_lshrrev_b32 v4, 3, v0
    v_and_b32 v5, 7, v0
    v_lshlrev_b32 v5, 4, v5
    v_lshl_or_b32 v4, v4, 8, v5
    s_bfe_u32 s40, s2, 0x10002
    s_lshr_b32 s41, s2, 3
    s_and_b32 s42, s2, 3
    s_lshl_b32 s42, s42, 5
    s_add_u32 s41, s41, s42
    s_lshl_b32 s45, s41, 15
    s_mov_b32 s10, 0x400000
    s_mov_b32 s11, 0x20000
    s_setprio 3
    s_waitcnt lgkmcnt(0)
    s_add_u32 s8, s18, 0xd00000
    s_addc_u32 s9, s19, 0
    buffer_load_dwordx4 v[0:3], v4, s[8:11], s45 offen
    buffer_load_dwordx4 v[4:7], v4, s[8:11], s45 offen offset:128
    s_add_u32 s24, s18, 0x3100000
    s_addc_u32 s25, s19, 0
    s_mov_b32 s26, 0x13000
    s_mov_b32 s27, 0x20000
    s_lshl_b32 s45, s3, 6
    s_add_u32 s45, s45, 73728
    v_lshlrev_b32 v25, 2, v64
    s_mov_b64 exec, 0xffff
    buffer_load_dword v24, v25, s[24:27], s45 offen
    s_mov_b64 exec, -1
    s_add_u32 s42, s3, 4
    s_mul_i32 s42, s42, 52
    s_lshr_b32 s42, s42, 8
    s_add_u32 s43, s3, 5
    s_mul_i32 s43, s43, 52
    s_lshr_b32 s43, s43, 8
    s_sub_u32 s43, s43, s42
    s_add_u32 s43, s43, 12
    s_mul_i32 s44, s3, 12
    s_add_u32 s42, s42, s44
    s_mul_i32 s44, s41, 196
L_isl_1:
    s_cbranch_execz L_isl_2
    s_add_u32 s44, s44, s42
    s_mov_b32 s20, s4
    s_mov_b32 s21, s5
    s_mov_b32 s22, 0x61a800
    s_mov_b32 s23, 0x20000
    s_lshl_b32 s45, s41, 18
    s_add_u32 s12, s18, s45
    s_addc_u32 s13, s19, 0
    s_add_u32 s12, s12, 0x1100000
    s_addc_u32 s13, s13, 0
    s_mov_b32 s14, 0x40000
    s_mov_b32 s15, 0x20000
    s_mul_i32 s45, s40, 6422528
    s_add_u32 s45, s45, 0
    s_add_u32 s16, s18, s45
    s_addc_u32 s17, s19, 0
    s_mov_b32 s18, 6422528
    s_mov_b32 s19, 0x20000
    s_mov_b32 s28, s6
    s_mov_b32 s29, s7
    s_mov_b32 s30, 0x61a800
    s_mov_b32 s31, 0x20000
    v_subrev_u32 v28, 80, v65
    v_and_b32 v29, 7, v28
    v_lshrrev_b32 v30, 4, v28
    v_and_b32 v28, 8, v28
    v_lshlrev_b32 v28, 1, v28
    v_mov_b32 v31, 0x3f80
    v_cmp_eq_u32 vcc, v29, v30
    v_lshlrev_b32 v31, v28, v31
    v_lshlrev_b32 v29, 2, v65
    v_cndmask_b32 v31, 0, v31, vcc
    s_cmp_lg_u32 s3, 1
    s_cbranch_scc1 L_k2_noal
    s_mov_b32 s46, 201328640
    v_writelane_b32 v31, s46, 5
L_k2_noal:
    v_cmp_gt_u32 vcc, 216, v65
    s_mov_b64 exec, vcc
    ds_write_b32 v29, v31
    s_cmp_lg_u32 s3, 0
    s_cbranch_scc1 L_k2_noz
    s_mov_b64 exec, 0xff
    v_add_u32 v29, 160768, v29
    ds_write_b32 v29, v31
L_k2_noz:
    s_mov_b64 exec, -1
L_isl_2:
    s_cbranch_execz L_isl_3
    v_bfe_u32 v28, v64, 2, 2
    v_and_b32 v29, 3, v64
    v_lshlrev_b32 v28, 10, v28
    v_lshl_or_b32 v28, v29, 4, v28
    v_lshrrev_b32 v29, 4, v64
    v_lshl_or_b32 v28, v29, 6, v28
    s_cmp_eq_u32 s43, 13
    s_cselect_b32 s50, -1, 0x0fff0fff
    s_lshl_b32 s45, s44, 8
    s_lshl_b32 s47, s3, 11
    s_add_u32 m0, s47, 125952
    s_mul_i32 s48, s40, 36864
    s_add_u32 s47, s47, s48
    v_mov_b32 v32, 0
    v_mov_b32 v33, 0
    v_mov_b32 v34, 0
    v_mov_b32 v35, 0
    v_mov_b32 v36, 0
    v_mov_b32 v37, 0
    v_mov_b32 v38, 0
    v_mov_b32 v39, 0
    v_mov_b32 v40, 0
    v_mov_b32 v41, 0
    v_mov_b32 v42, 0
    v_mov_b32 v43, 0
    v_mov_b32 v44, 0
    v_mov_b32 v45, 0
    v_mov_b32 v46, 0
    v_mov_b32 v47, 0
    s_waitcnt lgkmcnt(0)
    s_barrier
    s_cmp_lg_u32 s3, 15
    s_cbranch_scc1 L_k2_noc
    buffer_load_dwordx4 v66, s[24:27], s47 offen offset:2048 lds
    buffer_load_dwordx4 v66, s[24:27], s47 offen offset:3072 lds
L_k2_noc:
    buffer_load_dwordx4 v66, s[24:27], s47 offen lds
    buffer_load_dwordx4 v66, s[24:27], s47 offen offset:1024 lds
    v_mov_b32 v83, v28
    s_mov_b32 s84, s50
    s_mov_b32 s85, 0x0fff0fff
    s_mov_b32 s86, s45
    s_cmp_ge_u32 s3, 16
    s_cbranch_scc1 L_k2_xe
    s_mov_b32 exec_lo, s84
    s_mov_b32 exec_hi, s84
    buffer_load_dwordx4 v[32:35], v83, s[20:23], s86 offen offset:0
    s_mov_b32 exec_lo, s85
    s_mov_b32 exec_hi, s85
    buffer_load_dwordx4 v[36:39], v83, s[20:23], s86 offen offset:256
    buffer_load_dwordx4 v[40:43], v83, s[20:23], s86 offen offset:512
    buffer_load_dwordx4 v[44:47], v83, s[20:23], s86 offen offset:768
    s_mov_b64 exec, -1
L_k2_xe:
L_isl_3:
    s_cbranch_execz L_walkn
    v_and_b32 v28, 15, v64
    v_lshrrev_b32 v29, 4, v64
    v_lshlrev_b32 v120, 4, v28
    v_lshlrev_b32 v30, 3, v29
    v_add_u32 v121, 50176, v30
    v_add_u32 v122, 320, v30
    v_and_b32 v30, 3, v64
    v_lshlrev_b32 v30, 3, v30
    v_add_u32 v123, 320, v30
    s_mul_i32 s47, s3, 3072
    s_add_u32 s47, s47, 1024
    s_add_u32 s48, s47, 4
    v_and_b32 v30, 2, v28
    v_lshlrev_b32 v30, 2, v30
    v_bfe_u32 v31, v28, 2, 2
    v_lshl_add_u32 v30, v31, 1, v30
    v_and_or_b32 v30, v28, 1, v30
    v_lshl_add_u32 v125, v30, 3, s48
    v_and_b32 v30, 2, v31
    v_lshlrev_b32 v30, 2, v30
    v_lshl_add_u32 v30, v29, 1, v30
    v_and_or_b32 v30, v31, 1, v30
    v_lshl_add_u32 v124, v30, 3, s47
    v_lshrrev_b32 v30, 3, v65
    v_and_b32 v28, 7, v64
    v_lshl_add_u32 v29, v30, 6, v28
    v_lshl_or_b32 v28, v28, 16, v28
    v_mov_b32 v31, 1
    v_mov_b32 v30, 0x7fff00
    v_mov_b32 v25, 0
    v_mov_b32 v78, 0x0c0c0100
    v_mov_b32 v79, 0x202
    v_mov_b32 v80, 0x05040c00
    v_mov_b32 v81, 117760
    s_mov_b32 s50, 0x80808080
    s_mov_b32 s51, 0x80808080
    v_mov_b32 v72, 0
    s_mov_b32 s68, 0x0c040c00
    s_mov_b32 s69, 0x0c020c01
    s_mov_b32 s70, 0x01000100
L_isl_4:
    s_cbranch_execz L_isl_5
    s_mov_b32 s71, 0x03020302
    s_mov_b32 s72, 0x0c010c00
    s_cmp_lt_u32 s3, 16
    s_cbranch_scc1 L_k2_rw
    s_waitcnt vmcnt(2)
L_k2_rw:
    s_waitcnt vmcnt(6)
    s_mov_b64 exec, s[50:51]
    v_and_b32 v72, 0xff, v3
    v_perm_b32 v74, v3, v3, s69
    s_mov_b64 exec, -1
    v_mov_b32 v73, v72
    v_sad_u8 v75, v3, 0, 0
    v_cmp_le_i32 s[52:53], 0, v0
    v_cmp_le_i32 s[54:55], 0, v1
    v_cmp_le_i32 s[56:57], 0, v2
    v_cmp_le_i32 s[58:59], 0, v3
    v_add_u32_dpp v73, v73, v73 row_shr:8 row_mask:0xf bank_mask:0xf bound_ctrl:1
    v_mov_b32_dpp v75, v75 row_newbcast:7 row_mask:0xf bank_mask:0x3
    s_mov_b64 exec, s[50:51]
    ds_add_rtn_u32 v74, v25, v74 offset:276
    s_mov_b64 exec, -1
    v_add_u32_dpp v73, v73, v73 row_bcast:15 row_mask:0xa bank_mask:0xf
    v_mov_b32_dpp v75, v75 row_newbcast:15 row_mask:0xf bank_mask:0xc
    s_mov_b64 exec, 0xffff
    ds_or_b32 v25, v24 offset:256
    s_mov_b64 exec, -1
    v_add_u32_dpp v73, v73, v73 row_bcast:31 row_mask:0xc bank_mask:0xf
    v_cmp_lt_u32 s[76:77], 31, v75
    v_readlane_b32 s74, v73, 63
    v_sub_u32 v73, v73, v72
    s_andn2_b64 s[58:59], s[58:59], s[50:51]
    v_mov_b32 v72, s74
    s_mov_b64 exec, 1
    ds_add_rtn_u32 v72, v25, v72 offset:272
    s_mov_b64 exec, s[52:53]
    v_lshlrev_b32_sdwa v16, 2, v0 dst_sel:DWORD dst_unused:UNUSED_PAD src0_sel:DWORD src1_sel:BYTE_3
    v_bfe_u32 v56, v0, 24, 2
    ds_add_rtn_u32 v8, v16, v31 offset:0
    v_and_b32 v88, v30, v0
    v_mad_u32_u24 v56, v56, v79, v78
    s_mov_b64 exec, s[54:55]
    v_lshlrev_b32_sdwa v17, 2, v1 dst_sel:DWORD dst_unused:UNUSED_PAD src0_sel:DWORD src1_sel:BYTE_3
    v_bfe_u32 v57, v1, 24, 2
    ds_add_rtn_u32 v9, v17, v31 offset:0
    v_and_b32 v90, v30, v1
    v_mad_u32_u24 v57, v57, v79, v78
    s_mov_b64 exec, s[56:57]
    v_lshlrev_b32_sdwa v18, 2, v2 dst_sel:DWORD dst_unused:UNUSED_PAD src0_sel:DWORD src1_sel:BYTE_3
    v_bfe_u32 v58, v2, 24, 2
    ds_add_rtn_u32 v10, v18, v31 offset:0
    v_and_b32 v92, v30, v2
    v_mad_u32_u24 v58, v58, v79, v78
    s_mov_b64 exec, s[58:59]
    v_lshlrev_b32_sdwa v19, 2, v3 dst_sel:DWORD dst_unused:UNUSED_PAD src0_sel:DWORD src1_sel:BYTE_3
    v_bfe_u32 v59, v3, 24, 2
    ds_add_rtn_u32 v11, v19, v31 offset:0
    v_and_b32 v94, v30, v3
    v_mad_u32_u24 v59, v59, v79, v78
    s_mov_b64 s[60:61], 0
    s_mov_b64 s[62:63], 0
    s_mov_b64 s[64:65], 0
    s_mov_b64 s[66:67], 0
    s_mov_b64 exec, s[76:77]
    s_cbranch_execz L_k2_h1end
    v_cmp_le_i32 s[60:61], 0, v4
    v_cmp_le_i32 s[62:63], 0, v5
    v_cmp_le_i32 s[64:65], 0, v6
    v_cmp_le_i32 s[66:67], 0, v7
    s_mov_b64 exec, s[60:61]
    s_cbranch_execz L_k2h_13
    v_lshlrev_b32_sdwa v20, 2, v4 dst_sel:DWORD dst_unused:UNUSED_PAD src0_sel:DWORD src1_sel:BYTE_3
    v_bfe_u32 v60, v4, 24, 2
    ds_add_rtn_u32 v12, v20, v31 offset:0
    v_and_b32 v96, v30, v4
    v_mad_u32_u24 v60, v60, v79, v78
L_k2h_13:
    s_mov_b64 exec, s[62:63]
    s_cbranch_execz L_k2h_14
    v_lshlrev_b32_sdwa v21, 2, v5 dst_sel:DWORD dst_unused:UNUSED_PAD src0_sel:DWORD src1_sel:BYTE_3
    v_bfe_u32 v61, v5, 24, 2
    ds_add_rtn_u32 v13, v21, v31 offset:0
    v_and_b32 v98, v30, v5
    v_mad_u32_u24 v61, v61, v79, v78
L_k2h_14:
    s_mov_b64 exec, s[64:65]
    s_cbranch_execz L_k2h_15
    v_lshlrev_b32_sdwa v22, 2, v6 dst_sel:DWORD dst_unused:UNUSED_PAD src0_sel:DWORD src1_sel:BYTE_3
    v_bfe_u32 v62, v6, 24, 2
    ds_add_rtn_u32 v14, v22, v31 offset:0
    v_and_b32 v100, v30, v6
    v_mad_u32_u24 v62, v62, v79, v78
L_k2h_15:
    s_mov_b64 exec, s[66:67]
    s_cbranch_execz L_k2h_16
    v_lshlrev_b32_sdwa v23, 2, v7 dst_sel:DWORD dst_unused:UNUSED_PAD src0_sel:DWORD src1_sel:BYTE_3
    v_bfe_u32 v63, v7, 24, 2
    ds_add_rtn_u32 v15, v23, v31 offset:0
    v_and_b32 v102, v30, v7
    v_mad_u32_u24 v63, v63, v79, v78
L_k2h_16:
L_k2_h1end:
    s_mov_b64 exec, -1
L_isl_5:
    s_cbranch_execz L_isl_6
    v_lshl_add_u32 v82, v3, 8, v3
    v_perm_b32 v82, v82, v82, s72
    s_waitcnt vmcnt(4) lgkmcnt(0)
    v_readfirstlane_b32 s75, v72
    s_mov_b64 exec, 1
    ds_add_u32 v25, v31 offset:280
    s_mov_b64 exec, -1
    v_pk_sub_u16 v77, v74, v82
    v_add_u32 v73, s75, v73
    v_perm_b32 v76, v73, v73, s70
    v_mov_b32_dpp v77, v77 row_newbcast:7 row_mask:0xf bank_mask:0x3
    s_nop 0
    v_mov_b32_dpp v76, v76 row_newbcast:7 row_mask:0xf bank_mask:0x3
    v_mov_b32_dpp v77, v77 row_newbcast:15 row_mask:0xf bank_mask:0xc
    s_nop 0
    v_mov_b32_dpp v76, v76 row_newbcast:15 row_mask:0xf bank_mask:0xc
    v_pk_add_u16 v77, v77, v28
    v_pk_add_u16 v76, v76, v28
    s_mov_b64 exec, s[52:53]
    v_perm_b32 v24, v77, v76, v56
    v_mad_u32_u24 v8, v16, 24, v8
    v_lshlrev_b32 v8, 3, v8
    v_perm_b32 v89, v24, v0, v80
    v_lshl_add_u32 v24, v24, 1, v81
    ds_write_b64 v8, v[88:89] offset:1024
    ds_write_b16 v24, v29
    s_mov_b64 exec, s[54:55]
    v_perm_b32 v24, v77, v76, v57
    v_mad_u32_u24 v9, v17, 24, v9
    v_add_u32 v24, 8, v24
    v_lshlrev_b32 v9, 3, v9
    v_add_u32 v17, 8, v29
    v_perm_b32 v91, v24, v1, v80
    v_lshl_add_u32 v24, v24, 1, v81
    ds_write_b64 v9, v[90:91] offset:1024
    ds_write_b16 v24, v17
    s_mov_b64 exec, s[56:57]
    v_perm_b32 v24, v77, v76, v58
    v_mad_u32_u24 v10, v18, 24, v10
    v_add_u32 v24, 16, v24
    v_lshlrev_b32 v10, 3, v10
    v_add_u32 v18, 16, v29
    v_perm_b32 v93, v24, v2, v80
    v_lshl_add_u32 v24, v24, 1, v81
    ds_write_b64 v10, v[92:93] offset:1024
    ds_write_b16 v24, v18
    s_mov_b64 exec, s[58:59]
    v_perm_b32 v24, v77, v76, v59
    v_mad_u32_u24 v11, v19, 24, v11
    v_add_u32 v24, 24, v24
    v_lshlrev_b32 v11, 3, v11
    v_add_u32 v19, 24, v29
    v_perm_b32 v95, v24, v3, v80
    v_lshl_add_u32 v24, v24, 1, v81
    ds_write_b64 v11, v[94:95] offset:1024
    ds_write_b16 v24, v19
    s_cmp_eq_u64 s[76:77], 0
    s_cbranch_scc1 L_k2_s1end
    s_mov_b64 exec, s[60:61]
    s_cbranch_execz L_k2s_21
    v_perm_b32 v24, v77, v76, v60
    v_mad_u32_u24 v12, v20, 24, v12
    v_add_u32 v24, 31, v24
    v_lshlrev_b32 v12, 3, v12
    v_add_u32 v20, 31, v29
    v_perm_b32 v97, v24, v4, v80
    v_lshl_add_u32 v24, v24, 1, v81
    ds_write_b64 v12, v[96:97] offset:1024
    ds_write_b16 v24, v20
L_k2s_21:
    s_mov_b64 exec, s[62:63]
    s_cbranch_execz L_k2s_22
    v_perm_b32 v24, v77, v76, v61
    v_mad_u32_u24 v13, v21, 24, v13
    v_add_u32 v24, 39, v24
    v_lshlrev_b32 v13, 3, v13
    v_add_u32 v21, 39, v29
    v_perm_b32 v99, v24, v5, v80
    v_lshl_add_u32 v24, v24, 1, v81
    ds_write_b64 v13, v[98:99] offset:1024
    ds_write_b16 v24, v21
L_k2s_22:
    s_mov_b64 exec, s[64:65]
    s_cbranch_execz L_k2s_23
    v_perm_b32 v24, v77, v76, v62
    v_mad_u32_u24 v14, v22, 24, v14
    v_add_u32 v24, 47, v24
    v_lshlrev_b32 v14, 3, v14
    v_add_u32 v22, 47, v29
    v_perm_b32 v101, v24, v6, v80
    v_lshl_add_u32 v24, v24, 1, v81
    ds_write_b64 v14, v[100:101] offset:1024
    ds_write_b16 v24, v22
L_k2s_23:
    s_mov_b64 exec, s[66:67]
    s_cbranch_execz L_k2s_24
    v_perm_b32 v24, v77, v76, v63
    v_mad_u32_u24 v15, v23, 24, v15
    v_add_u32 v24, 55, v24
    v_lshlrev_b32 v15, 3, v15
    v_add_u32 v23, 55, v29
    v_perm_b32 v103, v24, v7, v80
    v_lshl_add_u32 v24, v24, 1, v81
    ds_write_b64 v15, v[102:103] offset:1024
    ds_write_b16 v24, v23
L_k2s_24:
L_k2_s1end:
    s_mov_b64 exec, -1
L_isl_6:
    s_cbranch_execz L_isl_7
    v_and_b32 v27, -2, v64
    s_lshl_b32 s45, s75, 1
    s_add_u32 s45, s45, 117760
    v_add_u32 v26, s45, v27
    v_and_b32 v28, 1, v64
    v_lshlrev_b32 v28, 4, v28
    v_lshrrev_b32 v29, 1, v64
    s_lshl_b32 s45, s75, 5
    s_add_u32 m0, s45, 50176
    ds_read_u16 v4, v26 offset:0
    ds_read_u16 v5, v26 offset:64
    ds_read_u16 v6, v26 offset:128
    ds_read_u16 v7, v26 offset:192
    s_add_u32 s46, s74, s75
    s_cmp_gt_u32 s46, 2048
    s_cselect_b32 s46, 0, s74
    s_waitcnt lgkmcnt(0)
    s_mov_b64 exec, 1
    ds_add_u32 v25, v31 offset:284
    s_mov_b64 exec, -1
    v_cmp_gt_i32 vcc, s46, v29
    v_lshl_add_u32 v4, v4, 5, v28
    s_cbranch_vccz L_k2_d0done
    s_mov_b64 exec, vcc
    buffer_load_dwordx4 v4, s[12:15], 0 offen  lds
    s_mov_b64 exec, -1
    s_sub_u32 s46, s46, 32
    s_add_u32 m0, m0, 1024
    v_cmp_gt_i32 vcc, s46, v29
    v_lshl_add_u32 v5, v5, 5, v28
    s_cbranch_vccz L_k2_d0done
    s_mov_b64 exec, vcc
    buffer_load_dwordx4 v5, s[12:15], 0 offen  lds
    s_mov_b64 exec, -1
    s_sub_u32 s46, s46, 32
    s_add_u32 m0, m0, 1024
    v_cmp_gt_i32 vcc, s46, v29
    v_lshl_add_u32 v6, v6, 5, v28
    s_cbranch_vccz L_k2_d0done
    s_mov_b64 exec, vcc
    buffer_load_dwordx4 v6, s[12:15], 0 offen  lds
    s_mov_b64 exec, -1
    s_sub_u32 s46, s46, 32
    s_add_u32 m0, m0, 1024
    v_cmp_gt_i32 vcc, s46, v29
    v_lshl_add_u32 v7, v7, 5, v28
L_isl_7:
    s_cbranch_execz L_walkn
    s_cbranch_vccz L_k2_d0done
    s_mov_b64 exec, vcc
    buffer_load_dwordx4 v7, s[12:15], 0 offen  lds
    s_mov_b64 exec, -1
    s_sub_u32 s46, s46, 32
    s_add_u32 m0, m0, 1024
    v_add_u32 v26, 256, v26
L_k2_d0more:
    v_cmp_gt_i32 vcc, s46, v29
    s_cbranch_vccz L_k2_d0done
    ds_read_u16 v4, v26
    v_add_u32 v26, 64, v26
    s_waitcnt lgkmcnt(0)
    v_lshl_add_u32 v4, v4, 5, v28
    s_mov_b64 exec, vcc
    buffer_load_dwordx4 v4, s[12:15], 0 offen  lds
    s_mov_b64 exec, -1
    s_sub_u32 s46, s46, 32
    s_add_u32 m0, m0, 1024
    s_branch L_k2_d0more
L_k2_d0done:
    s_setprio 0
    s_cmp_lt_u32 s3, 4
    s_cbranch_scc1 L_k2_ypd
    s_setprio 1
    s_cmp_lt_u32 s3, 8
    s_cbranch_scc1 L_k2_ypd
    s_setprio 2
    s_cmp_lt_u32 s3, 12
    s_cbranch_scc1 L_k2_ypd
    s_setprio 3
L_k2_ypd:
    v_add_u32 v67, 125952, v66
    v_lshrrev_b32 v68, 1, v66
    v_add_u32 v68, 158720, v68
    s_cmp_gt_u32 s74, 64
    s_cbranch_scc1 L_k2_x3
    s_waitcnt vmcnt(0)
L_k2_x3:
    s_waitcnt vmcnt(3)
    ds_read_b32 v0, v25 offset:280
    s_mov_b32 vcc_lo, 0x55555555
    s_mov_b32 vcc_hi, 0x55555555
    v_cndmask_b32_dpp v48, v36, v32, vcc quad_perm:[1,0,3,2] row_mask:0xf bank_mask:0xf
    v_cndmask_b32_dpp v49, v37, v33, vcc quad_perm:[1,0,3,2] row_mask:0xf bank_mask:0xf
    v_cndmask_b32_dpp v50, v38, v34, vcc quad_perm:[1,0,3,2] row_mask:0xf bank_mask:0xf
    v_cndmask_b32_dpp v51, v39, v35, vcc quad_perm:[1,0,3,2] row_mask:0xf bank_mask:0xf
    v_cndmask_b32_dpp v56, v44, v40, vcc quad_perm:[1,0,3,2] row_mask:0xf bank_mask:0xf
    v_cndmask_b32_dpp v57, v45, v41, vcc quad_perm:[1,0,3,2] row_mask:0xf bank_mask:0xf
    v_cndmask_b32_dpp v58, v46, v42, vcc quad_perm:[1,0,3,2] row_mask:0xf bank_mask:0xf
L_isl_8:
    s_cbranch_execz L_isl_9
    v_cndmask_b32_dpp v59, v47, v43, vcc quad_perm:[1,0,3,2] row_mask:0xf bank_mask:0xf
    s_mov_b32 vcc_lo, 0xaaaaaaaa
    s_mov_b32 vcc_hi, 0xaaaaaaaa
    v_cndmask_b32_dpp v52, v32, v36, vcc quad_perm:[1,0,3,2] row_mask:0xf bank_mask:0xf
    v_cndmask_b32_dpp v53, v33, v37, vcc quad_perm:[1,0,3,2] row_mask:0xf bank_mask:0xf
    v_cndmask_b32_dpp v54, v34, v38, vcc quad_perm:[1,0,3,2] row_mask:0xf bank_mask:0xf
    v_cndmask_b32_dpp v55, v35, v39, vcc quad_perm:[1,0,3,2] row_mask:0xf bank_mask:0xf
    v_cndmask_b32_dpp v60, v40, v44, vcc quad_perm:[1,0,3,2] row_mask:0xf bank_mask:0xf
    v_cndmask_b32_dpp v61, v41, v45, vcc quad_perm:[1,0,3,2] row_mask:0xf bank_mask:0xf
    v_cndmask_b32_dpp v62, v42, v46, vcc quad_perm:[1,0,3,2] row_mask:0xf bank_mask:0xf
    v_cndmask_b32_dpp v63, v43, v47, vcc quad_perm:[1,0,3,2] row_mask:0xf bank_mask:0xf
    s_mov_b32 vcc_lo, 0x33333333
    s_mov_b32 vcc_hi, 0x33333333
    v_cndmask_b32_dpp v104, v56, v48, vcc quad_perm:[2,3,0,1] row_mask:0xf bank_mask:0xf
    v_cndmask_b32_dpp v105, v57, v49, vcc quad_perm:[2,3,0,1] row_mask:0xf bank_mask:0xf
    v_cndmask_b32_dpp v106, v58, v50, vcc quad_perm:[2,3,0,1] row_mask:0xf bank_mask:0xf
    v_cndmask_b32_dpp v107, v59, v51, vcc quad_perm:[2,3,0,1] row_mask:0xf bank_mask:0xf
    v_cndmask_b32_dpp v108, v60, v52, vcc quad_perm:[2,3,0,1] row_mask:0xf bank_mask:0xf
    v_cndmask_b32_dpp v109, v61, v53, vcc quad_perm:[2,3,0,1] row_mask:0xf bank_mask:0xf
    v_cndmask_b32_dpp v110, v62, v54, vcc quad_perm:[2,3,0,1] row_mask:0xf bank_mask:0xf
    v_cndmask_b32_dpp v111, v63, v55, vcc quad_perm:[2,3,0,1] row_mask:0xf bank_mask:0xf
    s_mov_b32 vcc_lo, 0xcccccccc
    s_mov_b32 vcc_hi, 0xcccccccc
    v_cndmask_b32_dpp v112, v48, v56, vcc quad_perm:[2,3,0,1] row_mask:0xf bank_mask:0xf
    v_cndmask_b32_dpp v113, v49, v57, vcc quad_perm:[2,3,0,1] row_mask:0xf bank_mask:0xf
    v_cndmask_b32_dpp v114, v50, v58, vcc quad_perm:[2,3,0,1] row_mask:0xf bank_mask:0xf
    v_cndmask_b32_dpp v115, v51, v59, vcc quad_perm:[2,3,0,1] row_mask:0xf bank_mask:0xf
    v_cndmask_b32_dpp v116, v52, v60, vcc quad_perm:[2,3,0,1] row_mask:0xf bank_mask:0xf
    v_cndmask_b32_dpp v117, v53, v61, vcc quad_perm:[2,3,0,1] row_mask:0xf bank_mask:0xf
    v_cndmask_b32_dpp v118, v54, v62, vcc quad_perm:[2,3,0,1] row_mask:0xf bank_mask:0xf
    v_cndmask_b32_dpp v119, v55, v63, vcc quad_perm:[2,3,0,1] row_mask:0xf bank_mask:0xf
    s_waitcnt lgkmcnt(0)
    v_readfirstlane_b32 s45, v0
L_isl_9:
    s_cbranch_execz L_isl_10
    s_cmp_ge_u32 s45, 16
    s_cbranch_scc1 L_k2_wok
L_k2_spw:
    s_sleep 1
    ds_read_b32 v0, v25 offset:280
    s_waitcnt lgkmcnt(0)
    v_readfirstlane_b32 s45, v0
    s_cmp_lt_u32 s45, 16
    s_cbranch_scc1 L_k2_spw
L_k2_wok:
    ds_read_b64 v[88:89], v68 offset:0
    ds_read_b64 v[92:93], v68 offset:512
    ds_read_b64 v[96:97], v68 offset:1024
    ds_read_b64 v[100:101], v68 offset:1536
    ds_read_b128 v[32:35], v67 offset:0
    ds_read_b128 v[36:39], v67 offset:1024
    ds_read_b128 v[40:43], v67 offset:2048
    ds_read_b128 v[44:47], v67 offset:3072
    ds_read_b128 v[48:51], v67 offset:4096
    ds_read_b128 v[52:55], v67 offset:5120
    s_waitcnt lgkmcnt(4)
    v_mfma_f32_16x16x32_bf16 v[72:75], v[104:107], v[32:35], 0
    ds_read_b128 v[56:59], v67 offset:6144
    v_mfma_f32_16x16x32_bf16 v[72:75], v[108:111], v[36:39], v[72:75]
    ds_read_b128 v[60:63], v67 offset:7168
    s_waitcnt lgkmcnt(4)
    v_mfma_f32_16x16x32_bf16 v[72:75], v[112:115], v[40:43], v[72:75]
    ds_read_b128 v[32:35], v67 offset:8192
    v_mfma_f32_16x16x32_bf16 v[72:75], v[116:119], v[44:47], v[72:75]
    ds_read_b128 v[36:39], v67 offset:9216
    s_waitcnt lgkmcnt(4)
    v_mfma_f32_16x16x32_bf16 v[76:79], v[104:107], v[48:51], 0
    ds_read_b128 v[40:43], v67 offset:10240
    v_mfma_f32_16x16x32_bf16 v[76:79], v[108:111], v[52:55], v[76:79]
    ds_read_b128 v[44:47], v67 offset:11264
    s_waitcnt lgkmcnt(4)
    v_mfma_f32_16x16x32_bf16 v[76:79], v[112:115], v[56:59], v[76:79]
    ds_read_b128 v[48:51], v67 offset:12288
    v_mfma_f32_16x16x32_bf16 v[76:79], v[116:119], v[60:63], v[76:79]
    ds_read_b128 v[52:55], v67 offset:13312
L_isl_10:
    s_cbranch_execz L_isl_11
    s_waitcnt lgkmcnt(4)
    v_mfma_f32_16x16x32_bf16 v[80:83], v[104:107], v[32:35], 0
    ds_read_b128 v[56:59], v67 offset:14336
    v_mfma_f32_16x16x32_bf16 v[80:83], v[108:111], v[36:39], v[80:83]
    ds_read_b128 v[60:63], v67 offset:15360
    s_waitcnt lgkmcnt(4)
    v_mfma_f32_16x16x32_bf16 v[80:83], v[112:115], v[40:43], v[80:83]
    v_mfma_f32_16x16x32_bf16 v[80:83], v[116:119], v[44:47], v[80:83]
    s_waitcnt lgkmcnt(2)
    v_mfma_f32_16x16x32_bf16 v[84:87], v[104:107], v[48:51], 0
    v_mfma_f32_16x16x32_bf16 v[84:87], v[108:111], v[52:55], v[84:87]
    s_waitcnt lgkmcnt(0)
    v_mfma_f32_16x16x32_bf16 v[84:87], v[112:115], v[56:59], v[84:87]
    v_mfma_f32_16x16x32_bf16 v[84:87], v[116:119], v[60:63], v[84:87]
    v_lshlrev_b32 v24, 2, v64
    v_lshl_add_u32 v26, v24, 1, s47
    s_lshl_b32 s45, s3, 6
    s_add_u32 s45, s45, 117760
    v_add_u32 v27, s45, v27
L_k2_spl:
    ds_read_b32 v4, v25 offset:284
    ds_read_b32 v0, v24 offset:0
    ds_read_b32 v1, v25 offset:256
    ds_read_b64 v[2:3], v25 offset:272
    ds_read_b64 v[12:13], v26 offset:768
    ds_read_b64 v[16:17], v26 offset:1536
    ds_read_b64 v[20:21], v26 offset:2304
    ds_read_u16 v70, v27 offset:4096
    ds_read_u16 v126, v27 offset:6144
    ds_read_u16 v71, v27 offset:5120
    ds_read_u16 v127, v27 offset:7168
    s_waitcnt lgkmcnt(7)
    v_readfirstlane_b32 s46, v4
    s_lshl_b32 s45, s3, 2
    s_cmp_ge_u32 s46, 16
    s_cbranch_scc1 L_k2_lok
L_k2_spl2:
    s_sleep 1
    ds_read_b32 v0, v25 offset:284
    s_waitcnt lgkmcnt(0)
    v_readfirstlane_b32 s45, v0
    s_cmp_lt_u32 s45, 16
L_isl_11:
    s_cbranch_execz L_walkn
    s_cbranch_scc1 L_k2_spl2
    s_branch L_k2_spl
L_k2_lok:
    v_cmp_lt_u32 vcc, 96, v0
    v_readfirstlane_b32 s70, v1
    v_readfirstlane_b32 s76, v2
    v_readfirstlane_b32 s78, v3
    v_readlane_b32 s72, v0, s45
    s_add_u32 s45, s45, 1
    v_readlane_b32 s73, v0, s45
    s_add_u32 s45, s45, 1
    v_readlane_b32 s74, v0, s45
    s_add_u32 s45, s45, 1
    v_readlane_b32 s75, v0, s45
    s_add_u32 s45, s45, 1
    s_cmp_lg_u64 vcc, 0
    s_cbranch_scc1 L_k2_fallback
    s_cmp_lg_u32 s70, 0
    s_cbranch_scc1 L_k2_fallback
    s_and_b32 s77, s78, 0xffff
    s_lshr_b32 s78, s78, 16
    s_sub_u32 s77, s77, 2048
    s_sub_u32 s78, s78, 3072
    s_max_u32 s70, s77, s78
    s_cmp_gt_u32 s70, 1024
    s_cbranch_scc1 L_k2_fallback
    s_cmp_gt_u32 s76, 2048
    s_cbranch_scc1 L_k2_fallback
    s_add_u32 s79, s76, s77
    s_add_u32 s70, s79, s78
    s_cmp_gt_u32 s70, 3424
    s_cbranch_scc1 L_k2_fallback
    s_max_u32 s45, s73, s74
    s_max_u32 s45, s45, s75
    s_cmp_le_u32 s45, 64
    s_cbranch_scc1 L_k2_nolong
    ds_read_b64 v[14:15], v26 offset:1280
    ds_read_b64 v[18:19], v26 offset:2048
    ds_read_b64 v[22:23], v26 offset:2816
L_k2_nolong:
    s_mov_b32 s68, s72
    v_add_u32 v29, 64, v64
    s_sub_u32 s48, s76, 2048
    s_sub_u32 s49, s79, 3072
    s_lshl_b32 s48, s48, 16
    s_lshl_b32 s49, s49, 16
    s_waitcnt lgkmcnt(0)
    v_lshl_add_u32 v70, v70, 5, v28
    v_lshl_add_u32 v71, v71, 5, v28
L_isl_12:
    s_cbranch_execz L_isl_13
    v_lshl_add_u32 v126, v126, 5, v28
    v_lshl_add_u32 v127, v127, 5, v28
    v_lshl_add_u32 v24, s68, 3, v26
    s_add_u32 s68, s68, s73
    ds_write_b64 v24, v[12:13]
    s_cmp_le_u32 s73, 64
    s_cbranch_scc1 L_cp_25
    v_cmp_gt_u32 vcc, s73, v29
    s_mov_b64 exec, vcc
    ds_write_b64 v24, v[14:15] offset:512
    s_mov_b64 exec, -1
L_cp_25:
    v_add_u32 v17, s48, v17
    v_lshl_add_u32 v24, s68, 3, v26
    s_add_u32 s68, s68, s74
    ds_write_b64 v24, v[16:17]
    s_cmp_le_u32 s74, 64
    s_cbranch_scc1 L_cp_26
    v_add_u32 v19, s48, v19
    v_cmp_gt_u32 vcc, s74, v29
    s_mov_b64 exec, vcc
    ds_write_b64 v24, v[18:19] offset:512
    s_mov_b64 exec, -1
L_cp_26:
    v_add_u32 v21, s49, v21
    v_lshl_add_u32 v24, s68, 3, v26
    s_add_u32 s68, s68, s75
    ds_write_b64 v24, v[20:21]
    s_cmp_le_u32 s75, 64
    s_cbranch_scc1 L_cp_27
    v_add_u32 v23, s49, v23
    v_cmp_gt_u32 vcc, s75, v29
    s_mov_b64 exec, vcc
    ds_write_b64 v24, v[22:23] offset:512
    s_mov_b64 exec, -1
L_cp_27:
    s_sub_u32 s46, 0, s68
    s_and_b32 s46, s46, 31
    v_cmp_gt_u32 vcc, s46, v64
    v_lshl_add_u32 v24, s68, 3, v26
    v_mov_b32 v30, 6400000
    v_mov_b32 v31, 0xd800010
    s_mov_b64 exec, vcc
    ds_write_b64 v24, v[30:31]
    s_mov_b64 exec, -1
    s_add_u32 s69, s72, s73
    s_add_u32 s80, s69, s74
    s_lshr_b32 s69, s69, 4
    s_lshr_b32 s80, s80, 4
    s_add_u32 s68, s68, 15
    s_and_b32 s85, s68, 8
    s_lshr_b32 s68, s68, 4
L_isl_13:
    s_cbranch_execz L_isl_14
    s_add_u32 s84, s68, 1
    s_cmp_eq_u32 s85, 0
    s_cselect_b32 s84, s84, -1
    s_mov_b32 s48, 0xbfb8aa3b
    s_mov_b32 s49, 0xbfb8aa3b
    v_pk_mul_f32 v[72:73], s[48:49], v[72:73]
    v_pk_mul_f32 v[74:75], s[48:49], v[74:75]
    v_cvt_pk_bf16_f32 v90, v72, v73
    v_cvt_pk_bf16_f32 v91, v74, v75
    v_pk_mul_f32 v[76:77], s[48:49], v[76:77]
    v_pk_mul_f32 v[78:79], s[48:49], v[78:79]
    v_cvt_pk_bf16_f32 v94, v76, v77
    v_cvt_pk_bf16_f32 v95, v78, v79
    v_pk_mul_f32 v[80:81], s[48:49], v[80:81]
    v_pk_mul_f32 v[82:83], s[48:49], v[82:83]
    v_cvt_pk_bf16_f32 v98, v80, v81
    v_cvt_pk_bf16_f32 v99, v82, v83
    v_pk_mul_f32 v[84:85], s[48:49], v[84:85]
    v_pk_mul_f32 v[86:87], s[48:49], v[86:87]
    v_cvt_pk_bf16_f32 v102, v84, v85
    v_cvt_pk_bf16_f32 v103, v86, v87
    ds_read_b128 v[32:35], v67 offset:16384
    ds_read_b128 v[36:39], v67 offset:17408
    ds_read_b128 v[40:43], v67 offset:18432
    ds_read_b128 v[44:47], v67 offset:19456
    ds_read_b128 v[48:51], v67 offset:20480
    ds_read_b128 v[52:55], v67 offset:21504
    s_waitcnt lgkmcnt(4)
    v_mfma_f32_16x16x32_bf16 v[72:75], v[104:107], v[32:35], 0
    ds_read_b128 v[56:59], v67 offset:22528
    v_mfma_f32_16x16x32_bf16 v[72:75], v[108:111], v[36:39], v[72:75]
    ds_read_b128 v[60:63], v67 offset:23552
    s_waitcnt lgkmcnt(4)
    v_mfma_f32_16x16x32_bf16 v[72:75], v[112:115], v[40:43], v[72:75]
    ds_read_b128 v[32:35], v67 offset:24576
L_isl_14:
    s_cbranch_execz L_isl_15
    v_mfma_f32_16x16x32_bf16 v[72:75], v[116:119], v[44:47], v[72:75]
    ds_read_b128 v[36:39], v67 offset:25600
    s_waitcnt lgkmcnt(4)
    v_mfma_f32_16x16x32_bf16 v[76:79], v[104:107], v[48:51], 0
    ds_read_b128 v[40:43], v67 offset:26624
    v_mfma_f32_16x16x32_bf16 v[76:79], v[108:111], v[52:55], v[76:79]
    ds_read_b128 v[44:47], v67 offset:27648
    s_waitcnt lgkmcnt(4)
    v_mfma_f32_16x16x32_bf16 v[76:79], v[112:115], v[56:59], v[76:79]
    ds_read_b128 v[48:51], v67 offset:28672
    v_mfma_f32_16x16x32_bf16 v[76:79], v[116:119], v[60:63], v[76:79]
    ds_read_b128 v[52:55], v67 offset:29696
    s_waitcnt lgkmcnt(4)
    v_mfma_f32_16x16x32_bf16 v[80:83], v[104:107], v[32:35], 0
    ds_read_b128 v[56:59], v67 offset:30720
    v_mfma_f32_16x16x32_bf16 v[80:83], v[108:111], v[36:39], v[80:83]
    ds_read_b128 v[60:63], v67 offset:31744
    s_waitcnt lgkmcnt(4)
    v_mfma_f32_16x16x32_bf16 v[80:83], v[112:115], v[40:43], v[80:83]
    v_mfma_f32_16x16x32_bf16 v[80:83], v[116:119], v[44:47], v[80:83]
    s_waitcnt lgkmcnt(2)
    v_mfma_f32_16x16x32_bf16 v[84:87], v[104:107], v[48:51], 0
    v_mfma_f32_16x16x32_bf16 v[84:87], v[108:111], v[52:55], v[84:87]
    s_waitcnt lgkmcnt(0)
    v_mfma_f32_16x16x32_bf16 v[84:87], v[112:115], v[56:59], v[84:87]
    v_mfma_f32_16x16x32_bf16 v[84:87], v[116:119], v[60:63], v[84:87]
    ds_read_b64 v[68:69], v124
    ds_read_b64 v[114:115], v124 offset:128
    ds_read_b32 v112, v125
    ds_read_b32 v66, v125 offset:128
    s_lshl_b32 s45, s3, 5
    s_cmp_lt_u32 s45, s77
    s_cselect_b32 s71, 1, 0
    s_waitcnt vmcnt(0) lgkmcnt(0)
    v_mad_u32_u16 v113, v69, 32, v123
    v_mad_u32_u16 v119, v115, 32, v123
    s_setprio 3
    s_mov_b64 exec, 1
    ds_inc_u32 v120, v123 offset:268
    s_mov_b64 exec, -1
L_isl_15:
    s_cbranch_execz L_walkn
    v_or_b32_dpp v116, v68, v120 row_newbcast:0 row_mask:0xf bank_mask:0xf
    buffer_load_dwordx4 v[0:3], v116, s[16:19], 0 offen
    v_or_b32_dpp v117, v68, v120 row_newbcast:4 row_mask:0xf bank_mask:0xf
    buffer_load_dwordx4 v[4:7], v117, s[16:19], 0 offen
    v_or_b32_dpp v116, v68, v120 row_newbcast:8 row_mask:0xf bank_mask:0xf
    buffer_load_dwordx4 v[8:11], v116, s[16:19], 0 offen
    v_or_b32_dpp v117, v68, v120 row_newbcast:12 row_mask:0xf bank_mask:0xf
    buffer_load_dwordx4 v[12:15], v117, s[16:19], 0 offen
    v_or_b32_dpp v116, v114, v120 row_newbcast:0 row_mask:0xf bank_mask:0xf
    buffer_load_dwordx4 v[16:19], v116, s[16:19], 0 offen
    v_or_b32_dpp v117, v114, v120 row_newbcast:4 row_mask:0xf bank_mask:0xf
    buffer_load_dwordx4 v[20:23], v117, s[16:19], 0 offen
    v_or_b32_dpp v116, v114, v120 row_newbcast:8 row_mask:0xf bank_mask:0xf
    buffer_load_dwordx4 v[24:27], v116, s[16:19], 0 offen
    v_or_b32_dpp v117, v114, v120 row_newbcast:12 row_mask:0xf bank_mask:0xf
    buffer_load_dwordx4 v[28:31], v117, s[16:19], 0 offen
    v_mad_u32_u16 v117, v112, 32, v121 op_sel:[1,0,0,0]
    v_mad_u32_u16 v118, v112, 32, v122
L_k2_spinw:
    ds_read_b32 v116, v120 offset:268
    ds_read_b64 v[104:105], v117
    ds_read_b64 v[106:107], v118
    s_waitcnt lgkmcnt(0)
    v_readfirstlane_b32 s45, v116
    s_cmp_ge_u32 s45, 16
    s_cbranch_scc1 L_k2_eok
L_k2_spw2:
    s_sleep 1
    ds_read_b32 v116, v120 offset:268
    s_waitcnt lgkmcnt(0)
    v_readfirstlane_b32 s45, v116
    s_cmp_lt_u32 s45, 16
    s_cbranch_scc1 L_k2_spw2
    s_branch L_k2_spinw
L_k2_eok:
    s_lshl_b32 s45, s3, 5
    s_add_u32 s46, s45, s76
    s_lshl_b32 s46, s46, 5
    s_add_u32 m0, s46, 50176
    s_cmp_ge_u32 s45, s77
    s_cbranch_scc1 L_dma_p1
    buffer_load_dwordx4 v70, s[12:15], 0 offen  lds
    s_add_u32 s45, s45, 512
L_isl_16:
    s_cbranch_execz L_isl_17
    s_add_u32 m0, m0, 16384
    s_cmp_ge_u32 s45, s77
    s_cbranch_scc1 L_dma_p1
    buffer_load_dwordx4 v71, s[12:15], 0 offen  lds
L_dma_p1:
    s_max_u32 s81, s69, 2
    s_add_u32 s82, s81, 1
    s_mov_b32 s83, 3
    s_cmp_gt_u32 s69, 3
    s_cbranch_scc1 L_k2_nb0
    s_mov_b32 s83, 0
    s_waitcnt vmcnt(0)
    s_mov_b64 exec, 1
    ds_inc_u32 v120, v123 offset:260
    s_mov_b64 exec, -1
    s_setprio 2
    s_cmp_gt_u32 s69, 1
    s_cbranch_scc1 L_k2_nb0
L_k2_spinp:
    ds_read_b32 v117, v120 offset:260
    s_waitcnt lgkmcnt(0)
    v_readfirstlane_b32 s45, v117
    s_cmp_eq_u32 s45, 16
    s_cbranch_scc1 L_k2_okp
    s_sleep 1
    s_branch L_k2_spinp
L_k2_okp:
    s_cmp_gt_u32 s80, 1
    s_cbranch_scc1 L_k2_re0
    s_cmp_eq_u32 s81, -1
    s_cbranch_scc1 L_k2_issp
    s_lshl_b32 s45, s3, 5
    s_add_u32 s46, s45, s79
    s_lshl_b32 s46, s46, 5
    s_add_u32 m0, s46, 50176
    s_cmp_ge_u32 s45, s78
    s_cbranch_scc1 L_dma_ep
    buffer_load_dwordx4 v126, s[12:15], 0 offen  lds
    s_add_u32 s45, s45, 512
    s_add_u32 m0, m0, 16384
    s_cmp_ge_u32 s45, s78
    s_cbranch_scc1 L_dma_ep
    buffer_load_dwordx4 v127, s[12:15], 0 offen  lds
L_dma_ep:
    s_mov_b32 s81, -1
L_k2_issp:
    s_cmp_eq_u32 s82, -1
    s_cbranch_scc1 L_k2_arrp
    s_mov_b32 s82, -1
    s_waitcnt vmcnt(0)
    s_mov_b64 exec, 1
    ds_inc_u32 v120, v123 offset:264
    s_mov_b64 exec, -1
    s_setprio 1
L_k2_arrp:
L_k2_spincp:
    ds_read_b32 v117, v120 offset:264
    s_waitcnt lgkmcnt(0)
    v_readfirstlane_b32 s45, v117
    s_cmp_eq_u32 s45, 16
L_isl_17:
    s_cbranch_execz L_isl_18
    s_cbranch_scc1 L_k2_okcp
    s_sleep 1
    s_branch L_k2_spincp
L_k2_okcp:
L_k2_re0:
    v_mad_u32_u16 v117, v112, 32, v121 op_sel:[1,0,0,0]
    v_mad_u32_u16 v118, v112, 32, v122
    ds_read_b64 v[104:105], v117
    ds_read_b64 v[106:107], v118
    s_waitcnt lgkmcnt(0)
L_k2_nb0:
    s_mov_b32 s70, 2
    v_mfma_f32_16x16x32_bf16 v[32:35], v[104:107], v[88:91], 0
    v_mfma_f32_16x16x32_bf16 v[36:39], v[104:107], v[92:95], 0
    v_mfma_f32_16x16x32_bf16 v[40:43], v[104:107], v[96:99], 0
    v_mfma_f32_16x16x32_bf16 v[44:47], v[104:107], v[100:103], 0
    v_mad_u32_u16 v117, v66, 32, v121 op_sel:[1,0,0,0]
    v_mad_u32_u16 v118, v66, 32, v122
    ds_read_b64 v[104:105], v117
    ds_read_b64 v[106:107], v118
    s_cmp_eq_u32 s68, 0
    s_cbranch_scc1 L_k2_done
    s_add_u32 s71, s71, 2
    s_sub_u32 s87, s68, s71
    s_max_i32 s87, s87, 0
    s_cmp_lt_u32 s68, s71
    s_cselect_b32 s71, 0x40000000, s71
    s_sub_u32 s86, s68, 1
.p2align 6
L_k2_loop:
    ds_read_b64_tr_b16 v[108:109], v113
    ds_read_b64 v[114:115], v124 offset:256
    ds_read_b32 v112, v125 offset:256
    s_cmp_eq_u32 s70, s84
    s_cbranch_scc1 L_k2_ch0
L_k2_bh0:
    v_exp_f32 v50, v32
    v_exp_f32 v58, v33
    v_exp_f32 v64, v34
    v_exp_f32 v68, v35
    v_exp_f32 v51, v36
    v_exp_f32 v59, v37
    v_exp_f32 v65, v38
    v_exp_f32 v69, v39
    v_exp_f32 v54, v40
    v_exp_f32 v62, v41
    v_exp_f32 v66, v42
    v_exp_f32 v70, v43
    v_exp_f32 v55, v44
    v_exp_f32 v63, v45
    v_exp_f32 v67, v46
    v_exp_f32 v71, v47
    s_waitcnt lgkmcnt(0)
L_isl_18:
    s_cbranch_execz L_isl_19
    v_mfma_f32_16x16x32_bf16 v[32:35], v[104:107], v[88:91], 0
    v_mfma_f32_16x16x32_bf16 v[36:39], v[104:107], v[92:95], 0
    v_mfma_f32_16x16x32_bf16 v[40:43], v[104:107], v[96:99], 0
    v_mfma_f32_16x16x32_bf16 v[44:47], v[104:107], v[100:103], 0
    s_cmp_eq_u32 s70, s69
    s_cbranch_scc1 L_k2_ck00
L_k2_bk00:
    s_cmp_eq_u32 s70, s80
    s_cbranch_scc1 L_k2_ck10
L_k2_bk10:
    v_mad_u32_u16 v117, v112, 32, v121 op_sel:[1,0,0,0]
    v_mad_u32_u16 v118, v112, 32, v122
    ds_read_b64 v[104:105], v117
    ds_read_b64 v[106:107], v118
    v_mad_u32_u16 v113, v115, 32, v123
    s_sub_u32 s45, s70, s71
    s_cmp_gt_u32 s45, s87
    s_cbranch_scc1 L_k2_cw0
L_k2_bw0:
    s_waitcnt vmcnt(4)
L_k2_wd0:
    s_cmp_eq_u32 s70, s82
    s_cbranch_scc1 L_k2_ca10
L_k2_ba10:
    v_fma_mix_f32 v50, v0, v50, 1.0 op_sel_hi:[1,0,0]
    v_fma_mix_f32 v51, v1, v51, 1.0 op_sel_hi:[1,0,0]
    v_fma_mix_f32 v58, v4, v58, 1.0 op_sel_hi:[1,0,0]
    v_fma_mix_f32 v59, v5, v59, 1.0 op_sel_hi:[1,0,0]
    v_fma_mix_f32 v64, v8, v64, 1.0 op_sel_hi:[1,0,0]
    v_fma_mix_f32 v65, v9, v65, 1.0 op_sel_hi:[1,0,0]
    v_fma_mix_f32 v68, v12, v68, 1.0 op_sel_hi:[1,0,0]
    v_fma_mix_f32 v69, v13, v69, 1.0 op_sel_hi:[1,0,0]
    v_fma_mix_f32 v54, v2, v54, 1.0 op_sel_hi:[1,0,0]
    v_rcp_f32 v50, v50
    v_fma_mix_f32 v55, v3, v55, 1.0 op_sel_hi:[1,0,0]
    v_rcp_f32 v51, v51
    v_fma_mix_f32 v62, v6, v62, 1.0 op_sel_hi:[1,0,0]
    v_rcp_f32 v58, v58
    v_fma_mix_f32 v63, v7, v63, 1.0 op_sel_hi:[1,0,0]
    v_rcp_f32 v59, v59
    v_fma_mix_f32 v66, v10, v66, 1.0 op_sel_hi:[1,0,0]
    v_rcp_f32 v64, v64
    v_fma_mix_f32 v67, v11, v67, 1.0 op_sel_hi:[1,0,0]
    v_rcp_f32 v65, v65
    v_fma_mix_f32 v70, v14, v70, 1.0 op_sel_hi:[1,0,0]
L_isl_19:
    s_cbranch_execz L_walkn
    v_rcp_f32 v68, v68
    v_fma_mix_f32 v71, v15, v71, 1.0 op_sel_hi:[1,0,0]
    v_rcp_f32 v69, v69
    v_rcp_f32 v54, v54
    v_rcp_f32 v55, v55
    v_rcp_f32 v62, v62
    v_rcp_f32 v63, v63
    v_rcp_f32 v66, v66
    v_rcp_f32 v67, v67
    v_rcp_f32 v70, v70
    v_rcp_f32 v71, v71
    v_pk_mul_f32 v[50:51], v[50:51], v[0:1]
    v_pk_mul_f32 v[58:59], v[58:59], v[4:5]
    v_pk_mul_f32 v[64:65], v[64:65], v[8:9]
    v_pk_mul_f32 v[68:69], v[68:69], v[12:13]
    v_pk_mul_f32 v[54:55], v[54:55], v[2:3]
    v_pk_mul_f32 v[62:63], v[62:63], v[6:7]
    v_pk_mul_f32 v[66:67], v[66:67], v[10:11]
    v_pk_mul_f32 v[70:71], v[70:71], v[14:15]
    v_cvt_pk_bf16_f32 v48, v50, v58
    v_cvt_pk_bf16_f32 v56, v54, v62
    v_cvt_pk_bf16_f32 v52, v51, v59
    v_cvt_pk_bf16_f32 v60, v55, v63
    v_cvt_pk_bf16_f32 v49, v64, v68
    v_cvt_pk_bf16_f32 v53, v65, v69
    v_cvt_pk_bf16_f32 v57, v66, v70
    v_cvt_pk_bf16_f32 v61, v67, v71
    s_cmp_eq_u32 s70, s81
    s_cbranch_scc1 L_k2_ci0
L_k2_bi0:
    s_cmp_ge_i32 s70, s86
    s_cbranch_scc1 L_k2_ct0
L_k2_bt0:
    v_or_b32_dpp v116, v114, v120 row_newbcast:0 row_mask:0xf bank_mask:0xf
    buffer_load_dwordx4 v[0:3], v116, s[16:19], 0 offen
    v_or_b32_dpp v117, v114, v120 row_newbcast:4 row_mask:0xf bank_mask:0xf
    buffer_load_dwordx4 v[4:7], v117, s[16:19], 0 offen
    v_or_b32_dpp v116, v114, v120 row_newbcast:8 row_mask:0xf bank_mask:0xf
    buffer_load_dwordx4 v[8:11], v116, s[16:19], 0 offen
    v_or_b32_dpp v117, v114, v120 row_newbcast:12 row_mask:0xf bank_mask:0xf
    buffer_load_dwordx4 v[12:15], v117, s[16:19], 0 offen
L_k2_ng0:
L_isl_20:
    s_cbranch_execz L_isl_21
    s_add_u32 s70, s70, 1
    ds_read_b64_tr_b16 v[110:111], v119
    ds_read_b64 v[114:115], v124 offset:384
    ds_read_b32 v112, v125 offset:384
    v_add_u32 v124, 256, v124
    v_add_u32 v125, 256, v125
    s_cmp_eq_u32 s70, s84
    s_cbranch_scc1 L_k2_ch1
L_k2_bh1:
    v_exp_f32 v50, v32
    v_exp_f32 v58, v33
    v_exp_f32 v64, v34
    v_exp_f32 v68, v35
    v_exp_f32 v51, v36
    v_exp_f32 v59, v37
    v_exp_f32 v65, v38
    v_exp_f32 v69, v39
    v_exp_f32 v54, v40
    v_exp_f32 v62, v41
    v_exp_f32 v66, v42
    v_exp_f32 v70, v43
    v_exp_f32 v55, v44
    v_exp_f32 v63, v45
    v_exp_f32 v67, v46
    v_exp_f32 v71, v47
    s_waitcnt lgkmcnt(0)
    v_mfma_f32_16x16x32_bf16 v[32:35], v[104:107], v[88:91], 0
    v_mfma_f32_16x16x32_bf16 v[36:39], v[104:107], v[92:95], 0
    v_mfma_f32_16x16x32_bf16 v[40:43], v[104:107], v[96:99], 0
    v_mfma_f32_16x16x32_bf16 v[44:47], v[104:107], v[100:103], 0
    s_cmp_eq_u32 s70, s69
    s_cbranch_scc1 L_k2_ck01
L_k2_bk01:
    s_cmp_eq_u32 s70, s80
    s_cbranch_scc1 L_k2_ck11
L_k2_bk11:
    v_mad_u32_u16 v117, v112, 32, v121 op_sel:[1,0,0,0]
    v_mad_u32_u16 v118, v112, 32, v122
    ds_read_b64 v[104:105], v117
    ds_read_b64 v[106:107], v118
    v_mad_u32_u16 v119, v115, 32, v123
    s_sub_u32 s45, s70, s71
    s_cmp_gt_u32 s45, s87
    s_cbranch_scc1 L_k2_cw1
L_k2_bw1:
    s_waitcnt vmcnt(4)
L_k2_wd1:
    s_cmp_eq_u32 s70, s83
    s_cbranch_scc1 L_k2_ca0
L_k2_ba0:
    s_cmp_eq_u32 s70, s82
    s_cbranch_scc1 L_k2_ca11
L_k2_ba11:
    v_fma_mix_f32 v50, v16, v50, 1.0 op_sel_hi:[1,0,0]
    v_fma_mix_f32 v51, v17, v51, 1.0 op_sel_hi:[1,0,0]
L_isl_21:
    s_cbranch_execz L_isl_22
    v_fma_mix_f32 v58, v20, v58, 1.0 op_sel_hi:[1,0,0]
    v_fma_mix_f32 v59, v21, v59, 1.0 op_sel_hi:[1,0,0]
    v_fma_mix_f32 v64, v24, v64, 1.0 op_sel_hi:[1,0,0]
    v_fma_mix_f32 v65, v25, v65, 1.0 op_sel_hi:[1,0,0]
    v_fma_mix_f32 v68, v28, v68, 1.0 op_sel_hi:[1,0,0]
    v_fma_mix_f32 v69, v29, v69, 1.0 op_sel_hi:[1,0,0]
    v_fma_mix_f32 v54, v18, v54, 1.0 op_sel_hi:[1,0,0]
    v_rcp_f32 v50, v50
    v_fma_mix_f32 v55, v19, v55, 1.0 op_sel_hi:[1,0,0]
    v_rcp_f32 v51, v51
    v_fma_mix_f32 v62, v22, v62, 1.0 op_sel_hi:[1,0,0]
    v_rcp_f32 v58, v58
    v_fma_mix_f32 v63, v23, v63, 1.0 op_sel_hi:[1,0,0]
    v_rcp_f32 v59, v59
    v_fma_mix_f32 v66, v26, v66, 1.0 op_sel_hi:[1,0,0]
    v_rcp_f32 v64, v64
    v_fma_mix_f32 v67, v27, v67, 1.0 op_sel_hi:[1,0,0]
    v_rcp_f32 v65, v65
    v_fma_mix_f32 v70, v30, v70, 1.0 op_sel_hi:[1,0,0]
    v_rcp_f32 v68, v68
    v_fma_mix_f32 v71, v31, v71, 1.0 op_sel_hi:[1,0,0]
    v_rcp_f32 v69, v69
    v_rcp_f32 v54, v54
    v_rcp_f32 v55, v55
    v_rcp_f32 v62, v62
    v_rcp_f32 v63, v63
    v_rcp_f32 v66, v66
    v_rcp_f32 v67, v67
    v_rcp_f32 v70, v70
    v_rcp_f32 v71, v71
    v_pk_mul_f32 v[50:51], v[50:51], v[16:17]
    v_pk_mul_f32 v[58:59], v[58:59], v[20:21]
    v_pk_mul_f32 v[64:65], v[64:65], v[24:25]
    v_pk_mul_f32 v[68:69], v[68:69], v[28:29]
    v_pk_mul_f32 v[54:55], v[54:55], v[18:19]
    v_pk_mul_f32 v[62:63], v[62:63], v[22:23]
    v_pk_mul_f32 v[66:67], v[66:67], v[26:27]
    v_pk_mul_f32 v[70:71], v[70:71], v[30:31]
    v_cvt_pk_bf16_f32 v50, v50, v58
    v_cvt_pk_bf16_f32 v58, v54, v62
L_isl_22:
    s_cbranch_execz L_isl_23
    v_cvt_pk_bf16_f32 v54, v51, v59
    v_cvt_pk_bf16_f32 v62, v55, v63
    v_cvt_pk_bf16_f32 v51, v64, v68
    v_cvt_pk_bf16_f32 v55, v65, v69
    v_cvt_pk_bf16_f32 v59, v66, v70
    v_cvt_pk_bf16_f32 v63, v67, v71
    s_cmp_eq_u32 s70, s81
    s_cbranch_scc1 L_k2_ci1
L_k2_bi1:
    v_mfma_f32_16x16x32_bf16 v[72:75], v[108:111], v[48:51], v[72:75]
    v_mfma_f32_16x16x32_bf16 v[76:79], v[108:111], v[52:55], v[76:79]
    v_mfma_f32_16x16x32_bf16 v[80:83], v[108:111], v[56:59], v[80:83]
    v_mfma_f32_16x16x32_bf16 v[84:87], v[108:111], v[60:63], v[84:87]
    s_cmp_ge_i32 s70, s86
    s_cbranch_scc1 L_k2_ct1
L_k2_bt1:
    v_or_b32_dpp v116, v114, v120 row_newbcast:0 row_mask:0xf bank_mask:0xf
    buffer_load_dwordx4 v[16:19], v116, s[16:19], 0 offen
    v_or_b32_dpp v117, v114, v120 row_newbcast:4 row_mask:0xf bank_mask:0xf
    buffer_load_dwordx4 v[20:23], v117, s[16:19], 0 offen
    v_or_b32_dpp v116, v114, v120 row_newbcast:8 row_mask:0xf bank_mask:0xf
    buffer_load_dwordx4 v[24:27], v116, s[16:19], 0 offen
    v_or_b32_dpp v117, v114, v120 row_newbcast:12 row_mask:0xf bank_mask:0xf
    buffer_load_dwordx4 v[28:31], v117, s[16:19], 0 offen
L_k2_ng1:
    s_add_u32 s70, s70, 1
    s_branch L_k2_loop
L_k2_ch0:
    v_exp_f32 v50, v32
    v_exp_f32 v51, v36
    v_exp_f32 v58, v33
    v_exp_f32 v59, v37
    v_exp_f32 v54, v40
    v_exp_f32 v55, v44
    v_exp_f32 v62, v41
    v_exp_f32 v63, v45
    s_waitcnt vmcnt(0)
    v_fma_mix_f32 v50, v0, v50, 1.0 op_sel_hi:[1,0,0]
    v_fma_mix_f32 v51, v1, v51, 1.0 op_sel_hi:[1,0,0]
    v_fma_mix_f32 v58, v4, v58, 1.0 op_sel_hi:[1,0,0]
    v_fma_mix_f32 v59, v5, v59, 1.0 op_sel_hi:[1,0,0]
    v_fma_mix_f32 v54, v2, v54, 1.0 op_sel_hi:[1,0,0]
    v_fma_mix_f32 v55, v3, v55, 1.0 op_sel_hi:[1,0,0]
    v_fma_mix_f32 v62, v6, v62, 1.0 op_sel_hi:[1,0,0]
L_isl_23:
    s_cbranch_execz L_walkn
    v_fma_mix_f32 v63, v7, v63, 1.0 op_sel_hi:[1,0,0]
    v_rcp_f32 v50, v50
    v_rcp_f32 v51, v51
    v_rcp_f32 v58, v58
    v_rcp_f32 v59, v59
    v_rcp_f32 v54, v54
    v_rcp_f32 v55, v55
    v_rcp_f32 v62, v62
    v_rcp_f32 v63, v63
    s_nop 0
    v_pk_mul_f32 v[50:51], v[50:51], v[0:1]
    v_pk_mul_f32 v[58:59], v[58:59], v[4:5]
    v_pk_mul_f32 v[54:55], v[54:55], v[2:3]
    v_pk_mul_f32 v[62:63], v[62:63], v[6:7]
    v_cvt_pk_bf16_f32 v48, v50, v58
    v_cvt_pk_bf16_f32 v56, v54, v62
    v_cvt_pk_bf16_f32 v52, v51, v59
    v_cvt_pk_bf16_f32 v60, v55, v63
    v_mov_b32 v49, 0
    v_mov_b32 v53, 0
    v_mov_b32 v57, 0
    v_mov_b32 v61, 0
    s_waitcnt lgkmcnt(0)
    s_nop 0
    v_mfma_f32_16x16x16_bf16 v[72:75], v[108:109], v[48:49], v[72:75]
    v_mfma_f32_16x16x16_bf16 v[76:79], v[108:109], v[52:53], v[76:79]
    v_mfma_f32_16x16x16_bf16 v[80:83], v[108:109], v[56:57], v[80:83]
    v_mfma_f32_16x16x16_bf16 v[84:87], v[108:109], v[60:61], v[84:87]
    s_nop 3
    s_branch L_k2_done
    s_branch L_k2_bh0
L_k2_ck00:
L_k2_spin0:
    ds_read_b32 v117, v120 offset:260
    s_waitcnt lgkmcnt(0)
    v_readfirstlane_b32 s45, v117
    s_cmp_eq_u32 s45, 16
    s_cbranch_scc1 L_k2_ok0
    s_sleep 1
    s_branch L_k2_spin0
L_k2_ok0:
    s_branch L_k2_bk00
L_k2_ck10:
    s_cmp_eq_u32 s81, -1
    s_cbranch_scc1 L_k2_iss0
    s_lshl_b32 s45, s3, 5
    s_add_u32 s46, s45, s79
    s_lshl_b32 s46, s46, 5
    s_add_u32 m0, s46, 50176
    s_cmp_ge_u32 s45, s78
    s_cbranch_scc1 L_dma_e0
    buffer_load_dwordx4 v126, s[12:15], 0 offen  lds
L_isl_24:
    s_cbranch_execz L_isl_25
    s_add_u32 s45, s45, 512
    s_add_u32 m0, m0, 16384
    s_cmp_ge_u32 s45, s78
    s_cbranch_scc1 L_dma_e0
    buffer_load_dwordx4 v127, s[12:15], 0 offen  lds
L_dma_e0:
    s_mov_b32 s81, -1
L_k2_iss0:
    s_cmp_eq_u32 s82, -1
    s_cbranch_scc1 L_k2_arr0
    s_mov_b32 s82, -1
    s_waitcnt vmcnt(0)
    s_mov_b64 exec, 1
    ds_inc_u32 v120, v123 offset:264
    s_mov_b64 exec, -1
    s_setprio 1
L_k2_arr0:
L_k2_spinc0:
    ds_read_b32 v117, v120 offset:264
    s_waitcnt lgkmcnt(0)
    v_readfirstlane_b32 s45, v117
    s_cmp_eq_u32 s45, 16
    s_cbranch_scc1 L_k2_okc0
    s_sleep 1
    s_branch L_k2_spinc0
L_k2_okc0:
    s_branch L_k2_bk10
L_k2_cw0:
    s_cmp_gt_u32 s70, s68
    s_cbranch_scc1 L_k2_w00
    s_waitcnt vmcnt(5)
    s_branch L_k2_wd0
L_k2_w00:
    s_waitcnt vmcnt(0)
    s_branch L_k2_bw0
L_k2_ca10:
    s_mov_b32 s82, -1
    s_mov_b64 exec, 1
    ds_inc_u32 v120, v123 offset:264
    s_mov_b64 exec, -1
    s_setprio 1
    s_branch L_k2_ba10
L_k2_ci0:
    s_mov_b32 s81, -1
    s_lshl_b32 s45, s3, 5
    s_add_u32 s46, s45, s79
    s_lshl_b32 s46, s46, 5
    s_add_u32 m0, s46, 50176
    s_cmp_ge_u32 s45, s78
    s_cbranch_scc1 L_dma_i0
    buffer_load_dwordx4 v126, s[12:15], 0 offen  lds
    s_add_u32 s45, s45, 512
    s_add_u32 m0, m0, 16384
    s_cmp_ge_u32 s45, s78
    s_cbranch_scc1 L_dma_i0
    buffer_load_dwordx4 v127, s[12:15], 0 offen  lds
L_dma_i0:
    s_branch L_k2_bi0
L_k2_ct0:
    s_cmp_lg_u32 s82, -1
    s_cbranch_scc1 L_k2_t0
    s_setprio 0
L_k2_t0:
    s_cmp_lt_u32 s70, s68
    s_cbranch_scc1 L_k2_bt0
L_isl_25:
    s_cbranch_execz L_isl_26
    s_cmp_le_u32 s70, s68
    s_cbranch_scc1 L_k2_ng0
    v_mfma_f32_16x16x16_bf16 v[72:75], v[108:109], v[48:49], v[72:75]
    v_mfma_f32_16x16x16_bf16 v[76:79], v[108:109], v[52:53], v[76:79]
    v_mfma_f32_16x16x16_bf16 v[80:83], v[108:109], v[56:57], v[80:83]
    v_mfma_f32_16x16x16_bf16 v[84:87], v[108:109], v[60:61], v[84:87]
    s_nop 3
    s_branch L_k2_done
    s_branch L_k2_bt0
L_k2_ch1:
    v_exp_f32 v50, v32
    v_exp_f32 v51, v36
    v_exp_f32 v58, v33
    v_exp_f32 v59, v37
    v_exp_f32 v54, v40
    v_exp_f32 v55, v44
    v_exp_f32 v62, v41
    v_exp_f32 v63, v45
    s_waitcnt vmcnt(0)
    v_fma_mix_f32 v50, v16, v50, 1.0 op_sel_hi:[1,0,0]
    v_fma_mix_f32 v51, v17, v51, 1.0 op_sel_hi:[1,0,0]
    v_fma_mix_f32 v58, v20, v58, 1.0 op_sel_hi:[1,0,0]
    v_fma_mix_f32 v59, v21, v59, 1.0 op_sel_hi:[1,0,0]
    v_fma_mix_f32 v54, v18, v54, 1.0 op_sel_hi:[1,0,0]
    v_fma_mix_f32 v55, v19, v55, 1.0 op_sel_hi:[1,0,0]
    v_fma_mix_f32 v62, v22, v62, 1.0 op_sel_hi:[1,0,0]
    v_fma_mix_f32 v63, v23, v63, 1.0 op_sel_hi:[1,0,0]
    v_rcp_f32 v50, v50
    v_rcp_f32 v51, v51
    v_rcp_f32 v58, v58
    v_rcp_f32 v59, v59
    v_rcp_f32 v54, v54
    v_rcp_f32 v55, v55
    v_rcp_f32 v62, v62
    v_rcp_f32 v63, v63
    s_nop 0
    v_pk_mul_f32 v[50:51], v[50:51], v[16:17]
    v_pk_mul_f32 v[58:59], v[58:59], v[20:21]
    v_pk_mul_f32 v[54:55], v[54:55], v[18:19]
    v_pk_mul_f32 v[62:63], v[62:63], v[22:23]
    v_cvt_pk_bf16_f32 v50, v50, v58
    v_cvt_pk_bf16_f32 v58, v54, v62
    v_cvt_pk_bf16_f32 v54, v51, v59
    v_cvt_pk_bf16_f32 v62, v55, v63
    v_mov_b32 v51, 0
L_isl_26:
    s_cbranch_execz L_isl_27
    v_mov_b32 v55, 0
    v_mov_b32 v59, 0
    v_mov_b32 v63, 0
    s_waitcnt lgkmcnt(0)
    s_nop 0
    v_mfma_f32_16x16x32_bf16 v[72:75], v[108:111], v[48:51], v[72:75]
    v_mfma_f32_16x16x32_bf16 v[76:79], v[108:111], v[52:55], v[76:79]
    v_mfma_f32_16x16x32_bf16 v[80:83], v[108:111], v[56:59], v[80:83]
    v_mfma_f32_16x16x32_bf16 v[84:87], v[108:111], v[60:63], v[84:87]
    s_nop 3
    s_branch L_k2_done
    s_branch L_k2_bh1
L_k2_ck01:
L_k2_spin1:
    ds_read_b32 v117, v120 offset:260
    s_waitcnt lgkmcnt(0)
    v_readfirstlane_b32 s45, v117
    s_cmp_eq_u32 s45, 16
    s_cbranch_scc1 L_k2_ok1
    s_sleep 1
    s_branch L_k2_spin1
L_k2_ok1:
    s_branch L_k2_bk01
L_k2_ck11:
    s_cmp_eq_u32 s81, -1
    s_cbranch_scc1 L_k2_iss1
    s_lshl_b32 s45, s3, 5
    s_add_u32 s46, s45, s79
    s_lshl_b32 s46, s46, 5
    s_add_u32 m0, s46, 50176
    s_cmp_ge_u32 s45, s78
    s_cbranch_scc1 L_dma_e1
    buffer_load_dwordx4 v126, s[12:15], 0 offen  lds
    s_add_u32 s45, s45, 512
    s_add_u32 m0, m0, 16384
    s_cmp_ge_u32 s45, s78
    s_cbranch_scc1 L_dma_e1
    buffer_load_dwordx4 v127, s[12:15], 0 offen  lds
L_dma_e1:
    s_mov_b32 s81, -1
L_k2_iss1:
    s_cmp_eq_u32 s82, -1
    s_cbranch_scc1 L_k2_arr1
    s_mov_b32 s82, -1
    s_waitcnt vmcnt(0)
    s_mov_b64 exec, 1
    ds_inc_u32 v120, v123 offset:264
    s_mov_b64 exec, -1
    s_setprio 1
L_k2_arr1:
L_k2_spinc1:
    ds_read_b32 v117, v120 offset:264
    s_waitcnt lgkmcnt(0)
    v_readfirstlane_b32 s45, v117
    s_cmp_eq_u32 s45, 16
    s_cbranch_scc1 L_k2_okc1
    s_sleep 1
    s_branch L_k2_spinc1
L_k2_okc1:
    s_branch L_k2_bk11
L_k2_cw1:
    s_cmp_gt_u32 s70, s68
L_isl_27:
    s_cbranch_execz L_walkn
    s_cbranch_scc1 L_k2_w01
    s_waitcnt vmcnt(5)
    s_branch L_k2_wd1
L_k2_w01:
    s_waitcnt vmcnt(0)
    s_branch L_k2_bw1
L_k2_ca0:
    s_mov_b64 exec, 1
    ds_inc_u32 v120, v123 offset:260
    s_mov_b64 exec, -1
    s_setprio 2
    s_branch L_k2_ba0
L_k2_ca11:
    s_mov_b32 s82, -1
    s_mov_b64 exec, 1
    ds_inc_u32 v120, v123 offset:264
    s_mov_b64 exec, -1
    s_setprio 1
    s_branch L_k2_ba11
L_k2_ci1:
    s_mov_b32 s81, -1
    s_lshl_b32 s45, s3, 5
    s_add_u32 s46, s45, s79
    s_lshl_b32 s46, s46, 5
    s_add_u32 m0, s46, 50176
    s_cmp_ge_u32 s45, s78
    s_cbranch_scc1 L_dma_i1
    buffer_load_dwordx4 v126, s[12:15], 0 offen  lds
    s_add_u32 s45, s45, 512
    s_add_u32 m0, m0, 16384
    s_cmp_ge_u32 s45, s78
    s_cbranch_scc1 L_dma_i1
    buffer_load_dwordx4 v127, s[12:15], 0 offen  lds
L_dma_i1:
    s_branch L_k2_bi1
L_k2_ct1:
    s_cmp_lg_u32 s82, -1
    s_cbranch_scc1 L_k2_t1
    s_setprio 0
L_k2_t1:
    s_cmp_lt_u32 s70, s68
    s_cbranch_scc1 L_k2_bt1
    s_cmp_le_u32 s70, s68
    s_cbranch_scc1 L_k2_ng1
    s_branch L_k2_done
    s_branch L_k2_bt1
L_k2_done:
    s_waitcnt vmcnt(0)
    v_subrev_u32 v0, 320, v122
    v_lshrrev_b32 v0, 1, v0
    v_add_u32 v1, s44, v0
    v_lshlrev_b32 v1, 8, v1
    v_lshrrev_b32 v2, 1, v120
    s_lshl_b32 s45, s40, 7
    v_add3_u32 v1, v1, v2, s45
    v_mov_b32 v3, 0xbfb8aa3b
    v_mov_b32 v4, 0x80000000
    v_mov_b32 v2, v3
    v_pk_mul_f32 v[8:9], v[2:3], v[72:73]
    v_pk_mul_f32 v[10:11], v[2:3], v[76:77]
L_isl_28:
    s_cbranch_execz L_isl_29
    v_pk_mul_f32 v[12:13], v[2:3], v[80:81]
    v_pk_mul_f32 v[14:15], v[2:3], v[84:85]
    v_exp_f32 v8, v8
    v_exp_f32 v9, v9
    v_exp_f32 v10, v10
    v_exp_f32 v11, v11
    v_exp_f32 v12, v12
    v_exp_f32 v13, v13
    v_exp_f32 v14, v14
    v_exp_f32 v15, v15
    v_add_u32 v5, 0, v0
    v_cmp_gt_u32 vcc, s43, v5
    v_add_u32 v5, 1, v0
    v_cmp_gt_u32 s[46:47], s43, v5
    v_pk_add_f32 v[8:9], v[8:9], 1.0 op_sel_hi:[1,0]
    v_pk_add_f32 v[10:11], v[10:11], 1.0 op_sel_hi:[1,0]
    v_pk_add_f32 v[12:13], v[12:13], 1.0 op_sel_hi:[1,0]
    v_pk_add_f32 v[14:15], v[14:15], 1.0 op_sel_hi:[1,0]
    v_rcp_f32 v8, v8
    v_rcp_f32 v9, v9
    v_rcp_f32 v10, v10
    v_rcp_f32 v11, v11
    v_rcp_f32 v12, v12
    v_rcp_f32 v13, v13
    v_rcp_f32 v14, v14
    v_rcp_f32 v15, v15
    v_cndmask_b32 v16, v4, v1, vcc
    v_cndmask_b32 v17, v4, v1, s[46:47]
    v_pk_mul_f32 v[8:9], v[8:9], v[72:73]
    v_pk_mul_f32 v[10:11], v[10:11], v[76:77]
    v_pk_mul_f32 v[12:13], v[12:13], v[80:81]
    v_pk_mul_f32 v[14:15], v[14:15], v[84:85]
    v_cvt_pk_bf16_f32 v20, v8, v10
    v_cvt_pk_bf16_f32 v21, v12, v14
    buffer_store_dwordx2 v[20:21], v16, s[28:31], 0 offen offset:0 sc0 sc1
    v_cvt_pk_bf16_f32 v22, v9, v11
    v_cvt_pk_bf16_f32 v23, v13, v15
    buffer_store_dwordx2 v[22:23], v17, s[28:31], 0 offen offset:256 sc0 sc1
    v_pk_mul_f32 v[8:9], v[2:3], v[74:75]
    v_pk_mul_f32 v[10:11], v[2:3], v[78:79]
    v_pk_mul_f32 v[12:13], v[2:3], v[82:83]
    v_pk_mul_f32 v[14:15], v[2:3], v[86:87]
L_isl_29:
    s_cbranch_execz L_walkn
    v_exp_f32 v8, v8
    v_exp_f32 v9, v9
    v_exp_f32 v10, v10
    v_exp_f32 v11, v11
    v_exp_f32 v12, v12
    v_exp_f32 v13, v13
    v_exp_f32 v14, v14
    v_exp_f32 v15, v15
    v_add_u32 v5, 2, v0
    v_cmp_gt_u32 vcc, s43, v5
    v_add_u32 v5, 3, v0
    v_cmp_gt_u32 s[46:47], s43, v5
    v_pk_add_f32 v[8:9], v[8:9], 1.0 op_sel_hi:[1,0]
    v_pk_add_f32 v[10:11], v[10:11], 1.0 op_sel_hi:[1,0]
    v_pk_add_f32 v[12:13], v[12:13], 1.0 op_sel_hi:[1,0]
    v_pk_add_f32 v[14:15], v[14:15], 1.0 op_sel_hi:[1,0]
    v_rcp_f32 v8, v8
    v_rcp_f32 v9, v9
    v_rcp_f32 v10, v10
    v_rcp_f32 v11, v11
    v_rcp_f32 v12, v12
    v_rcp_f32 v13, v13
    v_rcp_f32 v14, v14
    v_rcp_f32 v15, v15
    v_cndmask_b32 v18, v4, v1, vcc
    v_cndmask_b32 v19, v4, v1, s[46:47]
    v_pk_mul_f32 v[8:9], v[8:9], v[74:75]
    v_pk_mul_f32 v[10:11], v[10:11], v[78:79]
    v_pk_mul_f32 v[12:13], v[12:13], v[82:83]
    v_pk_mul_f32 v[14:15], v[14:15], v[86:87]
    v_cvt_pk_bf16_f32 v24, v8, v10
    v_cvt_pk_bf16_f32 v25, v12, v14
    buffer_store_dwordx2 v[24:25], v18, s[28:31], 0 offen offset:512 sc0 sc1
    v_cvt_pk_bf16_f32 v26, v9, v11
    v_cvt_pk_bf16_f32 v27, v13, v15
    buffer_store_dwordx2 v[26:27], v19, s[28:31], 0 offen offset:768 sc0 sc1
    s_endpgm
L_k2_fallback:
    s_mov_b64 exec, -1
    s_load_dwordx2 s[50:51], s[0:1], 8
    s_load_dwordx4 s[52:55], s[0:1], 16
    s_load_dwordx4 s[56:59], s[0:1], 32
    s_load_dwordx2 s[60:61], s[0:1], 48
    s_waitcnt vmcnt(0) lgkmcnt(0)
    s_barrier
    s_mov_b32 s8, s50
    s_mov_b32 s9, s51
    s_mov_b32 s10, 0xc35000
    s_mov_b32 s11, 0x20000
    s_mov_b32 s12, s52
    s_mov_b32 s13, s53
    s_mov_b32 s14, 0x186a00
    s_mov_b32 s15, 0x20000
    s_mov_b32 s16, s54
    s_mov_b32 s17, s55
    s_mov_b32 s18, 0x186a00
    s_mov_b32 s19, 0x20000
    s_mov_b32 s24, s56
    s_mov_b32 s25, s57
    s_mov_b32 s26, 0x8000
    s_mov_b32 s27, 0x20000
    s_mov_b32 s32, s58
    s_mov_b32 s33, s59
    s_mov_b32 s34, 0x8000
    s_mov_b32 s35, 0x20000
    s_mov_b32 s36, s60
    s_mov_b32 s37, s61
    s_mov_b32 s38, 0x11000
    s_mov_b32 s39, 0x20000
    v_mov_b32 v0, 0
    v_mov_b32 v1, 0
    v_mov_b32 v2, 0
    v_mov_b32 v3, 0
    v_lshlrev_b32 v4, 4, v65
    ds_write_b128 v4, v[0:3]
    ds_write_b128 v4, v[0:3] offset:16384
    ds_write_b128 v4, v[0:3] offset:32768
    ds_write_b128 v4, v[0:3] offset:49152
    s_lshl_b32 s45, s40, 7
    v_lshl_add_u32 v5, v64, 1, s45
    v_lshlrev_b32 v6, 2, v64
    s_mul_i32 s46, s41, 196
    s_lshl_b32 s47, s3, 6
    s_waitcnt lgkmcnt(0)
    s_barrier
L_fb_chunk:
    s_cmp_ge_u32 s47, 400000
    s_cbranch_scc1 L_fb_fin
    s_lshl_b32 s48, s47, 2
    buffer_load_dword v7, v6, s[16:19], s48 offen
    buffer_load_dword v8, v6, s[12:15], s48 offen
    s_waitcnt vmcnt(0)
    v_subrev_u32 v9, s46, v7
    v_mov_b32 v10, 196
    v_cmp_gt_u32 s[62:63], v10, v9
L_fb_edge:
    s_cmp_eq_u64 s[62:63], 0
    s_cbranch_scc1 L_fb_next
    s_ff1_i32_b64 s49, s[62:63]
    s_bitset0_b64 s[62:63], s49
    v_readlane_b32 s64, v7, s49
    v_readlane_b32 s65, v8, s49
    s_add_u32 s66, s47, s49
    s_lshl_b32 s67, s64, 8
    s_lshl_b32 s68, s65, 8
    s_lshl_b32 s66, s66, 5
    s_nop 2
    buffer_load_dword v11, v6, s[20:23], s67 offen
    buffer_load_dword v12, v6, s[20:23], s68 offen
    v_and_b32 v14, 28, v6
    buffer_load_dword v13, v14, s[8:11], s66 offen
    v_mov_b32 v15, 0
    v_mov_b32 v16, 0
    s_mov_b32 s69, 0
    s_waitcnt vmcnt(0)
L_fb_k:
    s_lshl_b32 s70, s69, 9
    s_add_u32 s71, s70, 32768
    buffer_load_ushort v17, v5, s[36:39], s70 offen
    buffer_load_ushort v18, v5, s[36:39], s70 offen offset:256
    buffer_load_ushort v19, v5, s[36:39], s71 offen
    buffer_load_ushort v20, v5, s[36:39], s71 offen offset:256
    buffer_load_ushort v21, v5, s[32:35], s70 offen
    buffer_load_ushort v22, v5, s[32:35], s70 offen offset:256
    v_readlane_b32 s72, v11, s69
    v_readlane_b32 s73, v12, s69
    s_lshl_b32 s74, s72, 16
    s_and_b32 s72, s72, 0xffff0000
    s_lshl_b32 s75, s73, 16
    s_and_b32 s73, s73, 0xffff0000
    s_waitcnt vmcnt(0)
    v_lshlrev_b32 v17, 16, v17
    v_lshlrev_b32 v18, 16, v18
    v_lshlrev_b32 v19, 16, v19
    v_lshlrev_b32 v20, 16, v20
    v_lshlrev_b32 v21, 16, v21
    v_lshlrev_b32 v22, 16, v22
    v_fmac_f32 v15, s74, v17
    v_fmac_f32 v15, s72, v18
    v_fmac_f32 v15, s75, v19
    v_fmac_f32 v15, s73, v20
    v_fmac_f32 v16, s75, v21
    v_fmac_f32 v16, s73, v22
    s_add_u32 s69, s69, 1
    s_cmp_lt_u32 s69, 64
    s_cbranch_scc1 L_fb_k
    s_mov_b32 s69, 0
L_fb_ke:
    s_lshl_b32 s70, s69, 9
    s_add_u32 s70, s70, 65536
    buffer_load_ushort v17, v5, s[36:39], s70 offen
    buffer_load_ushort v18, v5, s[36:39], s70 offen offset:256
    v_readlane_b32 s72, v13, s69
    s_lshl_b32 s74, s72, 16
    s_and_b32 s72, s72, 0xffff0000
    s_waitcnt vmcnt(0)
    v_lshlrev_b32 v17, 16, v17
    v_lshlrev_b32 v18, 16, v18
    v_fmac_f32 v15, s74, v17
    v_fmac_f32 v15, s72, v18
    s_add_u32 s69, s69, 1
    s_cmp_lt_u32 s69, 8
    s_cbranch_scc1 L_fb_ke
    v_mul_f32 v15, 0xbfb8aa3b, v15
    v_exp_f32 v15, v15
    s_sub_u32 s64, s64, s46
    s_lshl_b32 s64, s64, 8
    v_add_f32 v15, 1.0, v15
    v_rcp_f32 v15, v15
    v_add_u32 v17, s64, v6
    v_mul_f32 v15, v15, v16
    ds_add_f32 v17, v15
    s_branch L_fb_edge
L_fb_next:
    s_add_u32 s47, s47, 1024
    s_branch L_fb_chunk
L_fb_fin:
    s_waitcnt lgkmcnt(0)
    s_barrier
    s_mov_b32 s47, s3
L_fb_node:
    s_cmp_ge_u32 s47, 196
    s_cbranch_scc1 L_k2_end
    s_add_u32 s64, s46, s47
    s_lshl_b32 s67, s64, 8
    buffer_load_dword v11, v6, s[20:23], s67 offen
    s_lshl_b32 s48, s47, 8
    v_add_u32 v17, s48, v6
    ds_read_b32 v15, v17
    s_mov_b32 s69, 0
    s_waitcnt vmcnt(0) lgkmcnt(0)
L_fb_ku:
    s_lshl_b32 s70, s69, 9
    buffer_load_ushort v17, v5, s[24:27], s70 offen
    buffer_load_ushort v18, v5, s[24:27], s70 offen offset:256
    v_readlane_b32 s72, v11, s69
    s_lshl_b32 s74, s72, 16
    s_and_b32 s72, s72, 0xffff0000
    s_waitcnt vmcnt(0)
    v_lshlrev_b32 v17, 16, v17
    v_lshlrev_b32 v18, 16, v18
    v_fmac_f32 v15, s74, v17
    v_fmac_f32 v15, s72, v18
    s_add_u32 s69, s69, 1
    s_cmp_lt_u32 s69, 64
    s_cbranch_scc1 L_fb_ku
    v_mul_f32 v16, 0xbfb8aa3b, v15
    v_exp_f32 v16, v16
    s_nop 0
    v_add_f32 v16, 1.0, v16
    v_rcp_f32 v16, v16
    s_nop 0
    v_mul_f32 v15, v15, v16
    v_cvt_pk_bf16_f32 v15, v15, v15
    buffer_store_short v15, v5, s[28:31], s67 offen
    s_add_u32 s47, s47, 16
    s_branch L_fb_node
L_k2_end:
    s_endpgm
.section .rodata,"a"
.p2align 6
.amdhsa_kernel prep_kernel
  .amdhsa_next_free_vgpr 128
  .amdhsa_next_free_sgpr 102
  .amdhsa_accum_offset 128
  .amdhsa_group_segment_fixed_size 0
  .amdhsa_kernarg_size 80
  .amdhsa_user_sgpr_count 2
  .amdhsa_user_sgpr_kernarg_segment_ptr 1
  .amdhsa_system_sgpr_workgroup_id_x 1
.end_amdhsa_kernel
.p2align 6
.amdhsa_kernel main_kernel
  .amdhsa_next_free_vgpr 128
  .amdhsa_next_free_sgpr 102
  .amdhsa_accum_offset 128
  .amdhsa_group_segment_fixed_size 0
  .amdhsa_kernarg_size 80
  .amdhsa_user_sgpr_count 2
  .amdhsa_user_sgpr_kernarg_segment_ptr 1
  .amdhsa_system_sgpr_workgroup_id_x 1
.end_amdhsa_kernel
```
